```python
import torch

def _softmax(x, axis=-1):
    return torch.softmax(x, dim=axis)
def _gelu(x):
    return torch.nn.functional.gelu(x, approximate="tanh")
def _silu(x):
    return torch.nn.functional.silu(x)
def _sigmoid(x):
    return torch.sigmoid(x)
def _layernorm(x, axis=-1, eps=1e-5):
    m = x.mean(dim=axis, keepdim=True)
    v = x.var(dim=axis, keepdim=True, unbiased=False)
    return (x - m) / torch.sqrt(v + eps)
def _scatter_add(tgt, idx, src, axis=0):
    return tgt.clone().index_add_(axis, idx, src)
def _segment_sum(src, seg, n):
    out = torch.zeros((n,) + src.shape[1:], dtype=src.dtype)
    return out.index_add_(0, seg, src)
def _pad(x, pw):
    flat = tuple(v for pair in reversed(pw) for v in pair)
    return torch.nn.functional.pad(x, flat)

kernel_name = 'parallel_sum__mha_block_cached__glu_gated_glu__decode'

def setup_inputs():

    _w = (lambda a: (lambda t: t.to(torch.bfloat16) if t.is_floating_point() else t)(torch.as_tensor(a)))
    def _A_setup():
        B, Sq, D = 1, 1, 512
        H, Sk, Dh = 32, 32768, 128
        return {
            "x": _w((lambda *s: torch.randn(*s, dtype=torch.bfloat16) * 0.05)(B, Sq, D)),
            "k_cache": _w((lambda *s: torch.randn(*s, dtype=torch.bfloat16) * 3.2)(B, H, Sk, Dh)),
            "v_cache": _w((lambda *s: torch.randn(*s, dtype=torch.bfloat16) * 1.6)(B, H, Sk, Dh)),
            "wq": _w((lambda *s: torch.randn(*s, dtype=torch.bfloat16) * 3.2)(D, H * Dh) * (D ** -0.5)),
            "wo": _w((lambda *s: torch.randn(*s, dtype=torch.bfloat16) * 1.6)(H * Dh, D) * ((H * Dh) ** -0.5)),
        }
    _A_in = _A_setup()

    def _B_setup():
        B, S, D, F = 1, 1, 512, 1792
        return {
            "x": _w((lambda *s: torch.randn(*s, dtype=torch.bfloat16) * 0.05)(B, S, D)),
            "w_gate": _w((lambda *s: torch.randn(*s, dtype=torch.bfloat16) * 0.8)(D, F)),
            "w_up": _w((lambda *s: torch.randn(*s, dtype=torch.bfloat16) * 0.05)(D, F)),
            "w_down": _w((lambda *s: torch.randn(*s, dtype=torch.bfloat16) * 0.05)(F, D)),
        }
    _B_in = _B_setup()

    return {
        "A_x": _A_in["x"],
        "A_k_cache": _A_in["k_cache"],
        "A_v_cache": _A_in["v_cache"],
        "A_wq": _A_in["wq"],
        "A_wo": _A_in["wo"],
        "B_x": _B_in["x"],
        "B_w_gate": _B_in["w_gate"],
        "B_w_up": _B_in["w_up"],
        "B_w_down": _B_in["w_down"],
    }

def reference(A_x, A_k_cache, A_v_cache, A_wq, A_wo, B_x, B_w_gate, B_w_up, B_w_down):
    def _A_ref(x, k_cache, v_cache, wq, wo):
        B, Sq, D = x.shape
        H, Dh = 32, 128
        q = (lambda x, *d: x.permute(*d))((x @ wq).reshape(B, Sq, H, Dh), 0, 2, 1, 3)
        scores = torch.einsum("bhqd,bhkd->bhqk", q, k_cache) * (Dh ** -0.5)
        p = _softmax(scores, axis=-1)
        o = torch.einsum("bhqk,bhkd->bhqd", p, v_cache)
        return (lambda x, *d: x.permute(*d))(o, 0, 2, 1, 3).reshape(B, Sq, H * Dh) @ wo

    def _B_ref(x, w_gate, w_up, w_down):
        g = torch.einsum("bsd,df->bsf", x, w_gate)
        u = torch.einsum("bsd,df->bsf", x, w_up)
        h = _sigmoid(g) * u
        return torch.einsum("bsf,fd->bsd", h, w_down)

    x = A_x
    xn = _layernorm(x, axis=-1)
    return x + _A_ref(xn, A_k_cache, A_v_cache, A_wq, A_wo) + _B_ref(xn, B_w_gate, B_w_up, B_w_down)
```

```asm
; @launch grid=(256,1,1) block=(768,1,1) lds=155648
.amdgcn_target "amdgcn-amd-amdhsa--gfx950"
.text
.globl parallel_sum__mha_block_cached__glu_gated_glu__decode_kernel
.p2align 8
.type parallel_sum__mha_block_cached__glu_gated_glu__decode_kernel,@function
parallel_sum__mha_block_cached__glu_gated_glu__decode_kernel:
    s_cmp_ge_u32 s2, 256
    s_cbranch_scc1 L_END
    s_load_dwordx16 s[16:31], s[0:1], 0
    s_load_dwordx8 s[32:39], s[0:1], 64
    v_and_b32 v1, 63, v0
    v_lshrrev_b32 v3, 6, v0
    v_lshlrev_b32 v2, 4, v1
    v_readfirstlane_b32 s5, v3
    s_and_b32 s3, s2, 7
    s_lshl_b32 s3, s3, 2
    s_bfe_u32 s4, s2, 0x20003
    s_add_u32 s3, s3, s4
    s_lshr_b32 s4, s2, 5
    s_mov_b32 s9, 0xffff0000
    v_mov_b32 v5, 0
    s_cmp_ge_u32 s5, 8
    s_cbranch_scc1 L_SVC
    s_getreg_b32 s10, hwreg(HW_REG_XCC_ID)
    s_mov_b32 s48, 0xaaaaaaaa
    s_mov_b32 s49, 0xaaaaaaaa
    s_mov_b32 s50, 0xcccccccc
    s_mov_b32 s51, 0xcccccccc
    s_lshl_b32 s52, s3, 23
    s_mul_i32 s60, s4, 32768
    s_add_u32 s52, s52, s60
    s_mul_i32 s60, s5, 4096
    s_add_u32 s52, s52, s60
    s_mov_b32 s8, 1048576
    s_mov_b32 s42, 268435456
    s_mov_b32 s43, 0x00020000
    s_mov_b32 s44, s52
    s_add_u32 s45, s44, 262144
    s_add_u32 s46, s44, 524288
    s_add_u32 s47, s44, 786432
    s_lshl_b32 s60, s5, 11
    v_lshlrev_b32 v6, 2, v1
    v_add_u32 v6, s60, v6
    v_mov_b32 v7, 0xff800000
    v_and_b32 v3, 15, v1
    v_lshlrev_b32 v3, 5, v3
    s_barrier
    s_waitcnt lgkmcnt(0)
    s_mov_b32 s40, s18
    s_mov_b32 s41, s19
    buffer_load_dwordx4 v[128:131], v2, s[40:43], s44 offen offset:0 nt
    buffer_load_dwordx4 v[132:135], v2, s[40:43], s44 offen offset:1024 nt
    buffer_load_dwordx4 v[136:139], v2, s[40:43], s44 offen offset:2048 nt
    buffer_load_dwordx4 v[140:143], v2, s[40:43], s44 offen offset:3072 nt
    s_waitcnt vmcnt(3)
    buffer_load_dwordx4 v[144:147], v2, s[40:43], s45 offen offset:0 nt
    s_waitcnt vmcnt(3)
    buffer_load_dwordx4 v[148:151], v2, s[40:43], s45 offen offset:1024 nt
    s_waitcnt vmcnt(3)
    buffer_load_dwordx4 v[152:155], v2, s[40:43], s45 offen offset:2048 nt
    s_waitcnt vmcnt(3)
    buffer_load_dwordx4 v[156:159], v2, s[40:43], s45 offen offset:3072 nt
    s_waitcnt vmcnt(3)
    buffer_load_dwordx4 v[64:67], v2, s[40:43], s46 offen offset:0 nt
    s_waitcnt vmcnt(3)
    buffer_load_dwordx4 v[68:71], v2, s[40:43], s46 offen offset:1024 nt
    s_waitcnt vmcnt(3)
    buffer_load_dwordx4 v[72:75], v2, s[40:43], s46 offen offset:2048 nt
    s_waitcnt vmcnt(3)
    buffer_load_dwordx4 v[76:79], v2, s[40:43], s46 offen offset:3072 nt
    s_waitcnt vmcnt(3)
    buffer_load_dwordx4 v[80:83], v2, s[40:43], s47 offen offset:0 nt
    s_waitcnt vmcnt(3)
    buffer_load_dwordx4 v[84:87], v2, s[40:43], s47 offen offset:1024 nt
    s_waitcnt vmcnt(3)
    buffer_load_dwordx4 v[88:91], v2, s[40:43], s47 offen offset:2048 nt
    s_waitcnt vmcnt(3)
    buffer_load_dwordx4 v[92:95], v2, s[40:43], s47 offen offset:3072 nt
    s_waitcnt vmcnt(3)
    s_add_u32 s44, s44, s8
    s_add_u32 s45, s44, 262144
    s_add_u32 s46, s44, 524288
    s_add_u32 s47, s44, 786432
    buffer_load_dwordx4 v[96:99], v2, s[40:43], s44 offen offset:0 nt
    s_waitcnt vmcnt(3)
    buffer_load_dwordx4 v[100:103], v2, s[40:43], s44 offen offset:1024 nt
    s_waitcnt vmcnt(3)
    buffer_load_dwordx4 v[104:107], v2, s[40:43], s44 offen offset:2048 nt
    s_waitcnt vmcnt(3)
    buffer_load_dwordx4 v[108:111], v2, s[40:43], s44 offen offset:3072 nt
    s_waitcnt vmcnt(3)
    buffer_load_dwordx4 v[112:115], v2, s[40:43], s45 offen offset:0 nt
    s_waitcnt vmcnt(3)
    buffer_load_dwordx4 v[116:119], v2, s[40:43], s45 offen offset:1024 nt
    s_waitcnt vmcnt(3)
    buffer_load_dwordx4 v[120:123], v2, s[40:43], s45 offen offset:2048 nt
    s_waitcnt vmcnt(3)
    buffer_load_dwordx4 v[124:127], v2, s[40:43], s45 offen offset:3072 nt
    s_mov_b32 s6, 0
L_QW:
    ds_read_b32 v4, v5 offset:1044
    s_add_u32 s6, s6, 1
    s_cmp_gt_u32 s6, 0x400000
    s_cbranch_scc1 L_QWOK
    s_waitcnt lgkmcnt(0)
    v_readfirstlane_b32 s60, v4
    s_cmp_ge_u32 s60, 4
    s_cbranch_scc1 L_QWOK
    s_branch L_QW
L_QWOK:
    s_waitcnt lgkmcnt(0)
    ds_read_b128 v[10:13], v3 offset:0
    ds_read_b128 v[14:17], v3 offset:16
    s_mov_b32 s60, 0x3e0293ee
    s_waitcnt lgkmcnt(0)
    v_mul_f32 v10, s60, v10
    v_mul_f32 v11, s60, v11
    v_mul_f32 v12, s60, v12
    v_mul_f32 v13, s60, v13
    v_mul_f32 v14, s60, v14
    v_mul_f32 v15, s60, v15
    v_mul_f32 v16, s60, v16
    v_mul_f32 v17, s60, v17
L_STREAME:
    v_lshlrev_b32 v26, 16, v128
    v_and_b32 v27, s9, v128
    v_lshlrev_b32 v28, 16, v129
    v_and_b32 v29, s9, v129
    v_lshlrev_b32 v30, 16, v130
    v_and_b32 v31, s9, v130
    v_lshlrev_b32 v32, 16, v131
    v_and_b32 v33, s9, v131
    s_waitcnt vmcnt(2)
    buffer_load_dwordx4 v[128:131], v2, s[40:43], s46 offen offset:0 nt
    v_mul_f32 v34, v26, v10
    v_fmac_f32 v34, v27, v11
    v_fmac_f32 v34, v28, v12
    v_fmac_f32 v34, v29, v13
    v_fmac_f32 v34, v30, v14
    v_fmac_f32 v34, v31, v15
    v_fmac_f32 v34, v32, v16
    v_fmac_f32 v34, v33, v17
    v_lshlrev_b32 v26, 16, v132
    v_and_b32 v27, s9, v132
    v_lshlrev_b32 v28, 16, v133
    v_and_b32 v29, s9, v133
    v_lshlrev_b32 v30, 16, v134
    v_and_b32 v31, s9, v134
    v_lshlrev_b32 v32, 16, v135
    v_and_b32 v33, s9, v135
    v_mul_f32 v35, v26, v10
    v_fmac_f32 v35, v27, v11
    v_fmac_f32 v35, v28, v12
    v_fmac_f32 v35, v29, v13
    v_fmac_f32 v35, v30, v14
    v_fmac_f32 v35, v31, v15
    v_fmac_f32 v35, v32, v16
    v_fmac_f32 v35, v33, v17
    v_lshlrev_b32 v26, 16, v136
    v_and_b32 v27, s9, v136
    v_lshlrev_b32 v28, 16, v137
    v_and_b32 v29, s9, v137
    v_lshlrev_b32 v30, 16, v138
    v_and_b32 v31, s9, v138
    v_lshlrev_b32 v32, 16, v139
    v_and_b32 v33, s9, v139
    s_waitcnt vmcnt(2)
    buffer_load_dwordx4 v[132:135], v2, s[40:43], s46 offen offset:1024 nt
    v_mul_f32 v36, v26, v10
    v_fmac_f32 v36, v27, v11
    v_fmac_f32 v36, v28, v12
    v_fmac_f32 v36, v29, v13
    v_fmac_f32 v36, v30, v14
    v_fmac_f32 v36, v31, v15
    v_fmac_f32 v36, v32, v16
    v_fmac_f32 v36, v33, v17
    v_lshlrev_b32 v26, 16, v140
    v_and_b32 v27, s9, v140
    v_lshlrev_b32 v28, 16, v141
    v_and_b32 v29, s9, v141
    v_lshlrev_b32 v30, 16, v142
    v_and_b32 v31, s9, v142
    v_lshlrev_b32 v32, 16, v143
    v_and_b32 v33, s9, v143
    v_mul_f32 v37, v26, v10
    v_fmac_f32 v37, v27, v11
    v_fmac_f32 v37, v28, v12
    v_fmac_f32 v37, v29, v13
    v_fmac_f32 v37, v30, v14
    v_fmac_f32 v37, v31, v15
    v_fmac_f32 v37, v32, v16
    v_fmac_f32 v37, v33, v17
    v_lshlrev_b32 v26, 16, v144
    v_and_b32 v27, s9, v144
    v_lshlrev_b32 v28, 16, v145
    v_and_b32 v29, s9, v145
    v_lshlrev_b32 v30, 16, v146
    v_and_b32 v31, s9, v146
    v_lshlrev_b32 v32, 16, v147
    v_and_b32 v33, s9, v147
    s_waitcnt vmcnt(2)
    buffer_load_dwordx4 v[136:139], v2, s[40:43], s46 offen offset:2048 nt
    v_mul_f32 v38, v26, v10
    v_fmac_f32 v38, v27, v11
    v_fmac_f32 v38, v28, v12
    v_fmac_f32 v38, v29, v13
    v_fmac_f32 v38, v30, v14
    v_fmac_f32 v38, v31, v15
    v_fmac_f32 v38, v32, v16
    v_fmac_f32 v38, v33, v17
    v_lshlrev_b32 v26, 16, v148
    v_and_b32 v27, s9, v148
    v_lshlrev_b32 v28, 16, v149
    v_and_b32 v29, s9, v149
    v_lshlrev_b32 v30, 16, v150
    v_and_b32 v31, s9, v150
    v_lshlrev_b32 v32, 16, v151
    v_and_b32 v33, s9, v151
    v_mul_f32 v39, v26, v10
    v_fmac_f32 v39, v27, v11
    v_fmac_f32 v39, v28, v12
    v_fmac_f32 v39, v29, v13
    v_fmac_f32 v39, v30, v14
    v_fmac_f32 v39, v31, v15
    v_fmac_f32 v39, v32, v16
    v_fmac_f32 v39, v33, v17
    v_lshlrev_b32 v26, 16, v152
    v_and_b32 v27, s9, v152
    v_lshlrev_b32 v28, 16, v153
    v_and_b32 v29, s9, v153
    v_lshlrev_b32 v30, 16, v154
    v_and_b32 v31, s9, v154
    v_lshlrev_b32 v32, 16, v155
    v_and_b32 v33, s9, v155
    s_waitcnt vmcnt(2)
    buffer_load_dwordx4 v[140:143], v2, s[40:43], s46 offen offset:3072 nt
    v_mul_f32 v40, v26, v10
    v_fmac_f32 v40, v27, v11
    v_fmac_f32 v40, v28, v12
    v_fmac_f32 v40, v29, v13
    v_fmac_f32 v40, v30, v14
    v_fmac_f32 v40, v31, v15
    v_fmac_f32 v40, v32, v16
    v_fmac_f32 v40, v33, v17
    v_lshlrev_b32 v26, 16, v156
    v_and_b32 v27, s9, v156
    v_lshlrev_b32 v28, 16, v157
    v_and_b32 v29, s9, v157
    v_lshlrev_b32 v30, 16, v158
    v_and_b32 v31, s9, v158
    v_lshlrev_b32 v32, 16, v159
    v_and_b32 v33, s9, v159
    v_mul_f32 v41, v26, v10
    v_fmac_f32 v41, v27, v11
    v_fmac_f32 v41, v28, v12
    v_fmac_f32 v41, v29, v13
    v_fmac_f32 v41, v30, v14
    v_fmac_f32 v41, v31, v15
    v_fmac_f32 v41, v32, v16
    v_fmac_f32 v41, v33, v17
    v_lshlrev_b32 v26, 16, v64
    v_and_b32 v27, s9, v64
    v_lshlrev_b32 v28, 16, v65
    v_and_b32 v29, s9, v65
    v_lshlrev_b32 v30, 16, v66
    v_and_b32 v31, s9, v66
    v_lshlrev_b32 v32, 16, v67
    v_and_b32 v33, s9, v67
    s_waitcnt vmcnt(2)
    buffer_load_dwordx4 v[144:147], v2, s[40:43], s47 offen offset:0 nt
    v_mul_f32 v42, v26, v10
    v_fmac_f32 v42, v27, v11
    v_fmac_f32 v42, v28, v12
    v_fmac_f32 v42, v29, v13
    v_fmac_f32 v42, v30, v14
    v_fmac_f32 v42, v31, v15
    v_fmac_f32 v42, v32, v16
    v_fmac_f32 v42, v33, v17
    v_lshlrev_b32 v26, 16, v68
    v_and_b32 v27, s9, v68
    v_lshlrev_b32 v28, 16, v69
    v_and_b32 v29, s9, v69
    v_lshlrev_b32 v30, 16, v70
    v_and_b32 v31, s9, v70
    v_lshlrev_b32 v32, 16, v71
    v_and_b32 v33, s9, v71
    v_mul_f32 v43, v26, v10
    v_fmac_f32 v43, v27, v11
    v_fmac_f32 v43, v28, v12
    v_fmac_f32 v43, v29, v13
    v_fmac_f32 v43, v30, v14
    v_fmac_f32 v43, v31, v15
    v_fmac_f32 v43, v32, v16
    v_fmac_f32 v43, v33, v17
    v_lshlrev_b32 v26, 16, v72
    v_and_b32 v27, s9, v72
    v_lshlrev_b32 v28, 16, v73
    v_and_b32 v29, s9, v73
    v_lshlrev_b32 v30, 16, v74
    v_and_b32 v31, s9, v74
    v_lshlrev_b32 v32, 16, v75
    v_and_b32 v33, s9, v75
    s_waitcnt vmcnt(2)
    buffer_load_dwordx4 v[148:151], v2, s[40:43], s47 offen offset:1024 nt
    v_mul_f32 v44, v26, v10
    v_fmac_f32 v44, v27, v11
    v_fmac_f32 v44, v28, v12
    v_fmac_f32 v44, v29, v13
    v_fmac_f32 v44, v30, v14
    v_fmac_f32 v44, v31, v15
    v_fmac_f32 v44, v32, v16
    v_fmac_f32 v44, v33, v17
    v_lshlrev_b32 v26, 16, v76
    v_and_b32 v27, s9, v76
    v_lshlrev_b32 v28, 16, v77
    v_and_b32 v29, s9, v77
    v_lshlrev_b32 v30, 16, v78
    v_and_b32 v31, s9, v78
    v_lshlrev_b32 v32, 16, v79
    v_and_b32 v33, s9, v79
    v_mul_f32 v45, v26, v10
    v_fmac_f32 v45, v27, v11
    v_fmac_f32 v45, v28, v12
    v_fmac_f32 v45, v29, v13
    v_fmac_f32 v45, v30, v14
    v_fmac_f32 v45, v31, v15
    v_fmac_f32 v45, v32, v16
    v_fmac_f32 v45, v33, v17
    v_lshlrev_b32 v26, 16, v80
    v_and_b32 v27, s9, v80
    v_lshlrev_b32 v28, 16, v81
    v_and_b32 v29, s9, v81
    v_lshlrev_b32 v30, 16, v82
    v_and_b32 v31, s9, v82
    v_lshlrev_b32 v32, 16, v83
    v_and_b32 v33, s9, v83
    s_waitcnt vmcnt(2)
    buffer_load_dwordx4 v[152:155], v2, s[40:43], s47 offen offset:2048 nt
    v_mul_f32 v46, v26, v10
    v_fmac_f32 v46, v27, v11
    v_fmac_f32 v46, v28, v12
    v_fmac_f32 v46, v29, v13
    v_fmac_f32 v46, v30, v14
    v_fmac_f32 v46, v31, v15
    v_fmac_f32 v46, v32, v16
    v_fmac_f32 v46, v33, v17
    v_lshlrev_b32 v26, 16, v84
    v_and_b32 v27, s9, v84
    v_lshlrev_b32 v28, 16, v85
    v_and_b32 v29, s9, v85
    v_lshlrev_b32 v30, 16, v86
    v_and_b32 v31, s9, v86
    v_lshlrev_b32 v32, 16, v87
    v_and_b32 v33, s9, v87
    v_mul_f32 v47, v26, v10
    v_fmac_f32 v47, v27, v11
    v_fmac_f32 v47, v28, v12
    v_fmac_f32 v47, v29, v13
    v_fmac_f32 v47, v30, v14
    v_fmac_f32 v47, v31, v15
    v_fmac_f32 v47, v32, v16
    v_fmac_f32 v47, v33, v17
    v_lshlrev_b32 v26, 16, v88
    v_and_b32 v27, s9, v88
    v_lshlrev_b32 v28, 16, v89
    v_and_b32 v29, s9, v89
    v_lshlrev_b32 v30, 16, v90
    v_and_b32 v31, s9, v90
    v_lshlrev_b32 v32, 16, v91
    v_and_b32 v33, s9, v91
    s_waitcnt vmcnt(2)
    buffer_load_dwordx4 v[156:159], v2, s[40:43], s47 offen offset:3072 nt
    v_mul_f32 v48, v26, v10
    v_fmac_f32 v48, v27, v11
    v_fmac_f32 v48, v28, v12
    v_fmac_f32 v48, v29, v13
    v_fmac_f32 v48, v30, v14
    v_fmac_f32 v48, v31, v15
    v_fmac_f32 v48, v32, v16
    v_fmac_f32 v48, v33, v17
    v_lshlrev_b32 v26, 16, v92
    v_and_b32 v27, s9, v92
    v_lshlrev_b32 v28, 16, v93
    v_and_b32 v29, s9, v93
    v_lshlrev_b32 v30, 16, v94
    v_and_b32 v31, s9, v94
    v_lshlrev_b32 v32, 16, v95
    v_and_b32 v33, s9, v95
    v_mul_f32 v49, v26, v10
    v_fmac_f32 v49, v27, v11
    v_fmac_f32 v49, v28, v12
    v_fmac_f32 v49, v29, v13
    v_fmac_f32 v49, v30, v14
    v_fmac_f32 v49, v31, v15
    v_fmac_f32 v49, v32, v16
    v_fmac_f32 v49, v33, v17
    s_nop 0
    v_add_f32_dpp v34, v34, v34 row_mirror row_mask:0xf bank_mask:0x3
    v_add_f32_dpp v34, v42, v42 row_mirror row_mask:0xf bank_mask:0xc
    v_add_f32_dpp v35, v35, v35 row_mirror row_mask:0xf bank_mask:0x3
    v_add_f32_dpp v35, v43, v43 row_mirror row_mask:0xf bank_mask:0xc
    v_add_f32_dpp v36, v36, v36 row_mirror row_mask:0xf bank_mask:0x3
    v_add_f32_dpp v36, v44, v44 row_mirror row_mask:0xf bank_mask:0xc
    v_add_f32_dpp v37, v37, v37 row_mirror row_mask:0xf bank_mask:0x3
    v_add_f32_dpp v37, v45, v45 row_mirror row_mask:0xf bank_mask:0xc
    v_add_f32_dpp v38, v38, v38 row_mirror row_mask:0xf bank_mask:0x3
    v_add_f32_dpp v38, v46, v46 row_mirror row_mask:0xf bank_mask:0xc
    v_add_f32_dpp v39, v39, v39 row_mirror row_mask:0xf bank_mask:0x3
    v_add_f32_dpp v39, v47, v47 row_mirror row_mask:0xf bank_mask:0xc
    v_add_f32_dpp v40, v40, v40 row_mirror row_mask:0xf bank_mask:0x3
    v_add_f32_dpp v40, v48, v48 row_mirror row_mask:0xf bank_mask:0xc
    v_add_f32_dpp v41, v41, v41 row_mirror row_mask:0xf bank_mask:0x3
    v_add_f32_dpp v41, v49, v49 row_mirror row_mask:0xf bank_mask:0xc
    s_nop 0
    v_add_f32_dpp v34, v34, v34 row_half_mirror row_mask:0xf bank_mask:0x5
    v_add_f32_dpp v34, v38, v38 row_half_mirror row_mask:0xf bank_mask:0xa
    v_add_f32_dpp v35, v35, v35 row_half_mirror row_mask:0xf bank_mask:0x5
    v_add_f32_dpp v35, v39, v39 row_half_mirror row_mask:0xf bank_mask:0xa
    v_add_f32_dpp v36, v36, v36 row_half_mirror row_mask:0xf bank_mask:0x5
    v_add_f32_dpp v36, v40, v40 row_half_mirror row_mask:0xf bank_mask:0xa
    v_add_f32_dpp v37, v37, v37 row_half_mirror row_mask:0xf bank_mask:0x5
    v_add_f32_dpp v37, v41, v41 row_half_mirror row_mask:0xf bank_mask:0xa
    s_nop 1
    v_add_f32_dpp v42, v34, v34 quad_perm:[3,2,1,0] row_mask:0xf bank_mask:0xf
    v_add_f32_dpp v43, v35, v35 quad_perm:[3,2,1,0] row_mask:0xf bank_mask:0xf
    v_add_f32_dpp v44, v36, v36 quad_perm:[3,2,1,0] row_mask:0xf bank_mask:0xf
    v_add_f32_dpp v45, v37, v37 quad_perm:[3,2,1,0] row_mask:0xf bank_mask:0xf
    s_nop 0
    v_cndmask_b32 v34, v42, v44, s[50:51]
    v_cndmask_b32 v35, v43, v45, s[50:51]
    s_nop 1
    v_add_f32_dpp v42, v34, v34 quad_perm:[1,0,3,2] row_mask:0xf bank_mask:0xf
    v_add_f32_dpp v43, v35, v35 quad_perm:[1,0,3,2] row_mask:0xf bank_mask:0xf
    s_nop 0
    v_cndmask_b32 v34, v42, v43, s[48:49]
    s_nop 0
    ds_write_b32 v6, v34 offset:8192
    v_max_f32 v7, v7, v34
    v_add_u32 v6, 256, v6
    v_lshlrev_b32 v26, 16, v96
    v_and_b32 v27, s9, v96
    v_lshlrev_b32 v28, 16, v97
    v_and_b32 v29, s9, v97
    v_lshlrev_b32 v30, 16, v98
    v_and_b32 v31, s9, v98
    v_lshlrev_b32 v32, 16, v99
    v_and_b32 v33, s9, v99
    s_waitcnt vmcnt(2)
    s_add_u32 s44, s44, s8
    s_add_u32 s45, s44, 262144
    s_add_u32 s46, s44, 524288
    s_add_u32 s47, s44, 786432
    buffer_load_dwordx4 v[64:67], v2, s[40:43], s44 offen offset:0 nt
    v_mul_f32 v34, v26, v10
    v_fmac_f32 v34, v27, v11
    v_fmac_f32 v34, v28, v12
    v_fmac_f32 v34, v29, v13
    v_fmac_f32 v34, v30, v14
    v_fmac_f32 v34, v31, v15
    v_fmac_f32 v34, v32, v16
    v_fmac_f32 v34, v33, v17
    v_lshlrev_b32 v26, 16, v100
    v_and_b32 v27, s9, v100
    v_lshlrev_b32 v28, 16, v101
    v_and_b32 v29, s9, v101
    v_lshlrev_b32 v30, 16, v102
    v_and_b32 v31, s9, v102
    v_lshlrev_b32 v32, 16, v103
    v_and_b32 v33, s9, v103
    v_mul_f32 v35, v26, v10
    v_fmac_f32 v35, v27, v11
    v_fmac_f32 v35, v28, v12
    v_fmac_f32 v35, v29, v13
    v_fmac_f32 v35, v30, v14
    v_fmac_f32 v35, v31, v15
    v_fmac_f32 v35, v32, v16
    v_fmac_f32 v35, v33, v17
    v_lshlrev_b32 v26, 16, v104
    v_and_b32 v27, s9, v104
    v_lshlrev_b32 v28, 16, v105
    v_and_b32 v29, s9, v105
    v_lshlrev_b32 v30, 16, v106
    v_and_b32 v31, s9, v106
    v_lshlrev_b32 v32, 16, v107
    v_and_b32 v33, s9, v107
    s_waitcnt vmcnt(2)
    buffer_load_dwordx4 v[68:71], v2, s[40:43], s44 offen offset:1024 nt
    v_mul_f32 v36, v26, v10
    v_fmac_f32 v36, v27, v11
    v_fmac_f32 v36, v28, v12
    v_fmac_f32 v36, v29, v13
    v_fmac_f32 v36, v30, v14
    v_fmac_f32 v36, v31, v15
    v_fmac_f32 v36, v32, v16
    v_fmac_f32 v36, v33, v17
    v_lshlrev_b32 v26, 16, v108
    v_and_b32 v27, s9, v108
    v_lshlrev_b32 v28, 16, v109
    v_and_b32 v29, s9, v109
    v_lshlrev_b32 v30, 16, v110
    v_and_b32 v31, s9, v110
    v_lshlrev_b32 v32, 16, v111
    v_and_b32 v33, s9, v111
    v_mul_f32 v37, v26, v10
    v_fmac_f32 v37, v27, v11
    v_fmac_f32 v37, v28, v12
    v_fmac_f32 v37, v29, v13
    v_fmac_f32 v37, v30, v14
    v_fmac_f32 v37, v31, v15
    v_fmac_f32 v37, v32, v16
    v_fmac_f32 v37, v33, v17
    v_lshlrev_b32 v26, 16, v112
    v_and_b32 v27, s9, v112
    v_lshlrev_b32 v28, 16, v113
    v_and_b32 v29, s9, v113
    v_lshlrev_b32 v30, 16, v114
    v_and_b32 v31, s9, v114
    v_lshlrev_b32 v32, 16, v115
    v_and_b32 v33, s9, v115
    v_mul_f32 v38, v26, v10
    v_fmac_f32 v38, v27, v11
    v_fmac_f32 v38, v28, v12
    v_fmac_f32 v38, v29, v13
    v_fmac_f32 v38, v30, v14
    v_fmac_f32 v38, v31, v15
    v_fmac_f32 v38, v32, v16
    v_fmac_f32 v38, v33, v17
    v_lshlrev_b32 v26, 16, v116
    v_and_b32 v27, s9, v116
    v_lshlrev_b32 v28, 16, v117
    v_and_b32 v29, s9, v117
    v_lshlrev_b32 v30, 16, v118
    v_and_b32 v31, s9, v118
    v_lshlrev_b32 v32, 16, v119
    v_and_b32 v33, s9, v119
    v_mul_f32 v39, v26, v10
    v_fmac_f32 v39, v27, v11
    v_fmac_f32 v39, v28, v12
    v_fmac_f32 v39, v29, v13
    v_fmac_f32 v39, v30, v14
    v_fmac_f32 v39, v31, v15
    v_fmac_f32 v39, v32, v16
    v_fmac_f32 v39, v33, v17
    v_lshlrev_b32 v26, 16, v120
    v_and_b32 v27, s9, v120
    v_lshlrev_b32 v28, 16, v121
    v_and_b32 v29, s9, v121
    v_lshlrev_b32 v30, 16, v122
    v_and_b32 v31, s9, v122
    v_lshlrev_b32 v32, 16, v123
    v_and_b32 v33, s9, v123
    v_mul_f32 v40, v26, v10
    v_fmac_f32 v40, v27, v11
    v_fmac_f32 v40, v28, v12
    v_fmac_f32 v40, v29, v13
    v_fmac_f32 v40, v30, v14
    v_fmac_f32 v40, v31, v15
    v_fmac_f32 v40, v32, v16
    v_fmac_f32 v40, v33, v17
    v_lshlrev_b32 v26, 16, v124
    v_and_b32 v27, s9, v124
    v_lshlrev_b32 v28, 16, v125
    v_and_b32 v29, s9, v125
    v_lshlrev_b32 v30, 16, v126
    v_and_b32 v31, s9, v126
    v_lshlrev_b32 v32, 16, v127
    v_and_b32 v33, s9, v127
    v_mul_f32 v41, v26, v10
    v_fmac_f32 v41, v27, v11
    v_fmac_f32 v41, v28, v12
    v_fmac_f32 v41, v29, v13
    v_fmac_f32 v41, v30, v14
    v_fmac_f32 v41, v31, v15
    v_fmac_f32 v41, v32, v16
    v_fmac_f32 v41, v33, v17
    v_lshlrev_b32 v26, 16, v128
    v_and_b32 v27, s9, v128
    v_lshlrev_b32 v28, 16, v129
    v_and_b32 v29, s9, v129
    v_lshlrev_b32 v30, 16, v130
    v_and_b32 v31, s9, v130
    v_lshlrev_b32 v32, 16, v131
    v_and_b32 v33, s9, v131
    v_mul_f32 v42, v26, v10
    v_fmac_f32 v42, v27, v11
    v_fmac_f32 v42, v28, v12
    v_fmac_f32 v42, v29, v13
    v_fmac_f32 v42, v30, v14
    v_fmac_f32 v42, v31, v15
    v_fmac_f32 v42, v32, v16
    v_fmac_f32 v42, v33, v17
    v_lshlrev_b32 v26, 16, v132
    v_and_b32 v27, s9, v132
    v_lshlrev_b32 v28, 16, v133
    v_and_b32 v29, s9, v133
    v_lshlrev_b32 v30, 16, v134
    v_and_b32 v31, s9, v134
    v_lshlrev_b32 v32, 16, v135
    v_and_b32 v33, s9, v135
    v_mul_f32 v43, v26, v10
    v_fmac_f32 v43, v27, v11
    v_fmac_f32 v43, v28, v12
    v_fmac_f32 v43, v29, v13
    v_fmac_f32 v43, v30, v14
    v_fmac_f32 v43, v31, v15
    v_fmac_f32 v43, v32, v16
    v_fmac_f32 v43, v33, v17
    v_lshlrev_b32 v26, 16, v136
    v_and_b32 v27, s9, v136
    v_lshlrev_b32 v28, 16, v137
    v_and_b32 v29, s9, v137
    v_lshlrev_b32 v30, 16, v138
    v_and_b32 v31, s9, v138
    v_lshlrev_b32 v32, 16, v139
    v_and_b32 v33, s9, v139
    v_mul_f32 v44, v26, v10
    v_fmac_f32 v44, v27, v11
    v_fmac_f32 v44, v28, v12
    v_fmac_f32 v44, v29, v13
    v_fmac_f32 v44, v30, v14
    v_fmac_f32 v44, v31, v15
    v_fmac_f32 v44, v32, v16
    v_fmac_f32 v44, v33, v17
    v_lshlrev_b32 v26, 16, v140
    v_and_b32 v27, s9, v140
    v_lshlrev_b32 v28, 16, v141
    v_and_b32 v29, s9, v141
    v_lshlrev_b32 v30, 16, v142
    v_and_b32 v31, s9, v142
    v_lshlrev_b32 v32, 16, v143
    v_and_b32 v33, s9, v143
    v_mul_f32 v45, v26, v10
    v_fmac_f32 v45, v27, v11
    v_fmac_f32 v45, v28, v12
    v_fmac_f32 v45, v29, v13
    v_fmac_f32 v45, v30, v14
    v_fmac_f32 v45, v31, v15
    v_fmac_f32 v45, v32, v16
    v_fmac_f32 v45, v33, v17
    v_lshlrev_b32 v26, 16, v144
    v_and_b32 v27, s9, v144
    v_lshlrev_b32 v28, 16, v145
    v_and_b32 v29, s9, v145
    v_lshlrev_b32 v30, 16, v146
    v_and_b32 v31, s9, v146
    v_lshlrev_b32 v32, 16, v147
    v_and_b32 v33, s9, v147
    v_mul_f32 v46, v26, v10
    v_fmac_f32 v46, v27, v11
    v_fmac_f32 v46, v28, v12
    v_fmac_f32 v46, v29, v13
    v_fmac_f32 v46, v30, v14
    v_fmac_f32 v46, v31, v15
    v_fmac_f32 v46, v32, v16
    v_fmac_f32 v46, v33, v17
    v_lshlrev_b32 v26, 16, v148
    v_and_b32 v27, s9, v148
    v_lshlrev_b32 v28, 16, v149
    v_and_b32 v29, s9, v149
    v_lshlrev_b32 v30, 16, v150
    v_and_b32 v31, s9, v150
    v_lshlrev_b32 v32, 16, v151
    v_and_b32 v33, s9, v151
    v_mul_f32 v47, v26, v10
    v_fmac_f32 v47, v27, v11
    v_fmac_f32 v47, v28, v12
    v_fmac_f32 v47, v29, v13
    v_fmac_f32 v47, v30, v14
    v_fmac_f32 v47, v31, v15
    v_fmac_f32 v47, v32, v16
    v_fmac_f32 v47, v33, v17
    v_lshlrev_b32 v26, 16, v152
    v_and_b32 v27, s9, v152
    v_lshlrev_b32 v28, 16, v153
    v_and_b32 v29, s9, v153
    v_lshlrev_b32 v30, 16, v154
    v_and_b32 v31, s9, v154
    v_lshlrev_b32 v32, 16, v155
    v_and_b32 v33, s9, v155
    v_mul_f32 v48, v26, v10
    v_fmac_f32 v48, v27, v11
    v_fmac_f32 v48, v28, v12
    v_fmac_f32 v48, v29, v13
    v_fmac_f32 v48, v30, v14
    v_fmac_f32 v48, v31, v15
    v_fmac_f32 v48, v32, v16
    v_fmac_f32 v48, v33, v17
    s_waitcnt vmcnt(2)
    v_lshlrev_b32 v26, 16, v156
    v_and_b32 v27, s9, v156
    v_lshlrev_b32 v28, 16, v157
    v_and_b32 v29, s9, v157
    v_lshlrev_b32 v30, 16, v158
    v_and_b32 v31, s9, v158
    v_lshlrev_b32 v32, 16, v159
    v_and_b32 v33, s9, v159
    v_mul_f32 v49, v26, v10
    v_fmac_f32 v49, v27, v11
    v_fmac_f32 v49, v28, v12
    v_fmac_f32 v49, v29, v13
    v_fmac_f32 v49, v30, v14
    v_fmac_f32 v49, v31, v15
    v_fmac_f32 v49, v32, v16
    v_fmac_f32 v49, v33, v17
    s_nop 0
    v_add_f32_dpp v34, v34, v34 row_mirror row_mask:0xf bank_mask:0x3
    v_add_f32_dpp v34, v42, v42 row_mirror row_mask:0xf bank_mask:0xc
    v_add_f32_dpp v35, v35, v35 row_mirror row_mask:0xf bank_mask:0x3
    v_add_f32_dpp v35, v43, v43 row_mirror row_mask:0xf bank_mask:0xc
    v_add_f32_dpp v36, v36, v36 row_mirror row_mask:0xf bank_mask:0x3
    v_add_f32_dpp v36, v44, v44 row_mirror row_mask:0xf bank_mask:0xc
    v_add_f32_dpp v37, v37, v37 row_mirror row_mask:0xf bank_mask:0x3
    v_add_f32_dpp v37, v45, v45 row_mirror row_mask:0xf bank_mask:0xc
    v_add_f32_dpp v38, v38, v38 row_mirror row_mask:0xf bank_mask:0x3
    v_add_f32_dpp v38, v46, v46 row_mirror row_mask:0xf bank_mask:0xc
    v_add_f32_dpp v39, v39, v39 row_mirror row_mask:0xf bank_mask:0x3
    v_add_f32_dpp v39, v47, v47 row_mirror row_mask:0xf bank_mask:0xc
    v_add_f32_dpp v40, v40, v40 row_mirror row_mask:0xf bank_mask:0x3
    v_add_f32_dpp v40, v48, v48 row_mirror row_mask:0xf bank_mask:0xc
    v_add_f32_dpp v41, v41, v41 row_mirror row_mask:0xf bank_mask:0x3
    v_add_f32_dpp v41, v49, v49 row_mirror row_mask:0xf bank_mask:0xc
    s_nop 0
    v_add_f32_dpp v34, v34, v34 row_half_mirror row_mask:0xf bank_mask:0x5
    v_add_f32_dpp v34, v38, v38 row_half_mirror row_mask:0xf bank_mask:0xa
    v_add_f32_dpp v35, v35, v35 row_half_mirror row_mask:0xf bank_mask:0x5
    v_add_f32_dpp v35, v39, v39 row_half_mirror row_mask:0xf bank_mask:0xa
    v_add_f32_dpp v36, v36, v36 row_half_mirror row_mask:0xf bank_mask:0x5
    v_add_f32_dpp v36, v40, v40 row_half_mirror row_mask:0xf bank_mask:0xa
    v_add_f32_dpp v37, v37, v37 row_half_mirror row_mask:0xf bank_mask:0x5
    v_add_f32_dpp v37, v41, v41 row_half_mirror row_mask:0xf bank_mask:0xa
    s_nop 1
    v_add_f32_dpp v42, v34, v34 quad_perm:[3,2,1,0] row_mask:0xf bank_mask:0xf
    v_add_f32_dpp v43, v35, v35 quad_perm:[3,2,1,0] row_mask:0xf bank_mask:0xf
    v_add_f32_dpp v44, v36, v36 quad_perm:[3,2,1,0] row_mask:0xf bank_mask:0xf
    v_add_f32_dpp v45, v37, v37 quad_perm:[3,2,1,0] row_mask:0xf bank_mask:0xf
    s_nop 0
    v_cndmask_b32 v34, v42, v44, s[50:51]
    v_cndmask_b32 v35, v43, v45, s[50:51]
    s_nop 1
    v_add_f32_dpp v42, v34, v34 quad_perm:[1,0,3,2] row_mask:0xf bank_mask:0xf
    v_add_f32_dpp v43, v35, v35 quad_perm:[1,0,3,2] row_mask:0xf bank_mask:0xf
    s_nop 0
    v_cndmask_b32 v34, v42, v43, s[48:49]
    s_nop 0
    ds_write_b32 v6, v34 offset:8192
    v_max_f32 v7, v7, v34
    v_add_u32 v6, 256, v6
    s_mov_b32 s6, 2
L_KLOOPE:
    s_waitcnt vmcnt(1)
    buffer_load_dwordx4 v[72:75], v2, s[40:43], s44 offen offset:2048 nt
    buffer_load_dwordx4 v[76:79], v2, s[40:43], s44 offen offset:3072 nt
    v_lshlrev_b32 v26, 16, v64
    v_and_b32 v27, s9, v64
    v_lshlrev_b32 v28, 16, v65
    v_and_b32 v29, s9, v65
    v_lshlrev_b32 v30, 16, v66
    v_and_b32 v31, s9, v66
    v_lshlrev_b32 v32, 16, v67
    v_and_b32 v33, s9, v67
    v_mul_f32 v34, v26, v10
    v_fmac_f32 v34, v27, v11
    v_fmac_f32 v34, v28, v12
    v_fmac_f32 v34, v29, v13
    v_fmac_f32 v34, v30, v14
    v_fmac_f32 v34, v31, v15
    v_fmac_f32 v34, v32, v16
    v_fmac_f32 v34, v33, v17
    s_waitcnt vmcnt(2)
    buffer_load_dwordx4 v[80:83], v2, s[40:43], s45 offen offset:0 nt
    v_lshlrev_b32 v26, 16, v68
    v_and_b32 v27, s9, v68
    v_lshlrev_b32 v28, 16, v69
    v_and_b32 v29, s9, v69
    v_lshlrev_b32 v30, 16, v70
    v_and_b32 v31, s9, v70
    v_lshlrev_b32 v32, 16, v71
    v_and_b32 v33, s9, v71
    v_mul_f32 v35, v26, v10
    v_fmac_f32 v35, v27, v11
    v_fmac_f32 v35, v28, v12
    v_fmac_f32 v35, v29, v13
    v_fmac_f32 v35, v30, v14
    v_fmac_f32 v35, v31, v15
    v_fmac_f32 v35, v32, v16
    v_fmac_f32 v35, v33, v17
    s_waitcnt vmcnt(2)
    buffer_load_dwordx4 v[84:87], v2, s[40:43], s45 offen offset:1024 nt
    v_lshlrev_b32 v26, 16, v72
    v_and_b32 v27, s9, v72
    v_lshlrev_b32 v28, 16, v73
    v_and_b32 v29, s9, v73
    v_lshlrev_b32 v30, 16, v74
    v_and_b32 v31, s9, v74
    v_lshlrev_b32 v32, 16, v75
    v_and_b32 v33, s9, v75
    v_mul_f32 v36, v26, v10
    v_fmac_f32 v36, v27, v11
    v_fmac_f32 v36, v28, v12
    v_fmac_f32 v36, v29, v13
    v_fmac_f32 v36, v30, v14
    v_fmac_f32 v36, v31, v15
    v_fmac_f32 v36, v32, v16
    v_fmac_f32 v36, v33, v17
    s_waitcnt vmcnt(2)
    v_lshlrev_b32 v26, 16, v76
    v_and_b32 v27, s9, v76
    v_lshlrev_b32 v28, 16, v77
    v_and_b32 v29, s9, v77
    v_lshlrev_b32 v30, 16, v78
    v_and_b32 v31, s9, v78
    v_lshlrev_b32 v32, 16, v79
    v_and_b32 v33, s9, v79
    v_mul_f32 v37, v26, v10
    v_fmac_f32 v37, v27, v11
    v_fmac_f32 v37, v28, v12
    v_fmac_f32 v37, v29, v13
    v_fmac_f32 v37, v30, v14
    v_fmac_f32 v37, v31, v15
    v_fmac_f32 v37, v32, v16
    v_fmac_f32 v37, v33, v17
    s_waitcnt vmcnt(1)
    buffer_load_dwordx4 v[88:91], v2, s[40:43], s45 offen offset:2048 nt
    buffer_load_dwordx4 v[92:95], v2, s[40:43], s45 offen offset:3072 nt
    v_lshlrev_b32 v26, 16, v80
    v_and_b32 v27, s9, v80
    v_lshlrev_b32 v28, 16, v81
    v_and_b32 v29, s9, v81
    v_lshlrev_b32 v30, 16, v82
    v_and_b32 v31, s9, v82
    v_lshlrev_b32 v32, 16, v83
    v_and_b32 v33, s9, v83
    v_mul_f32 v38, v26, v10
    v_fmac_f32 v38, v27, v11
    v_fmac_f32 v38, v28, v12
    v_fmac_f32 v38, v29, v13
    v_fmac_f32 v38, v30, v14
    v_fmac_f32 v38, v31, v15
    v_fmac_f32 v38, v32, v16
    v_fmac_f32 v38, v33, v17
    s_waitcnt vmcnt(2)
    buffer_load_dwordx4 v[96:99], v2, s[40:43], s46 offen offset:0 nt
    v_lshlrev_b32 v26, 16, v84
    v_and_b32 v27, s9, v84
    v_lshlrev_b32 v28, 16, v85
    v_and_b32 v29, s9, v85
    v_lshlrev_b32 v30, 16, v86
    v_and_b32 v31, s9, v86
    v_lshlrev_b32 v32, 16, v87
    v_and_b32 v33, s9, v87
    v_mul_f32 v39, v26, v10
    v_fmac_f32 v39, v27, v11
    v_fmac_f32 v39, v28, v12
    v_fmac_f32 v39, v29, v13
    v_fmac_f32 v39, v30, v14
    v_fmac_f32 v39, v31, v15
    v_fmac_f32 v39, v32, v16
    v_fmac_f32 v39, v33, v17
    s_waitcnt vmcnt(2)
    buffer_load_dwordx4 v[100:103], v2, s[40:43], s46 offen offset:1024 nt
    v_lshlrev_b32 v26, 16, v88
    v_and_b32 v27, s9, v88
    v_lshlrev_b32 v28, 16, v89
    v_and_b32 v29, s9, v89
    v_lshlrev_b32 v30, 16, v90
    v_and_b32 v31, s9, v90
    v_lshlrev_b32 v32, 16, v91
    v_and_b32 v33, s9, v91
    v_mul_f32 v40, v26, v10
    v_fmac_f32 v40, v27, v11
    v_fmac_f32 v40, v28, v12
    v_fmac_f32 v40, v29, v13
    v_fmac_f32 v40, v30, v14
    v_fmac_f32 v40, v31, v15
    v_fmac_f32 v40, v32, v16
    v_fmac_f32 v40, v33, v17
    s_waitcnt vmcnt(2)
    v_lshlrev_b32 v26, 16, v92
    v_and_b32 v27, s9, v92
    v_lshlrev_b32 v28, 16, v93
    v_and_b32 v29, s9, v93
    v_lshlrev_b32 v30, 16, v94
    v_and_b32 v31, s9, v94
    v_lshlrev_b32 v32, 16, v95
    v_and_b32 v33, s9, v95
    v_mul_f32 v41, v26, v10
    v_fmac_f32 v41, v27, v11
    v_fmac_f32 v41, v28, v12
    v_fmac_f32 v41, v29, v13
    v_fmac_f32 v41, v30, v14
    v_fmac_f32 v41, v31, v15
    v_fmac_f32 v41, v32, v16
    v_fmac_f32 v41, v33, v17
    s_waitcnt vmcnt(1)
    buffer_load_dwordx4 v[104:107], v2, s[40:43], s46 offen offset:2048 nt
    buffer_load_dwordx4 v[108:111], v2, s[40:43], s46 offen offset:3072 nt
    v_lshlrev_b32 v26, 16, v96
    v_and_b32 v27, s9, v96
    v_lshlrev_b32 v28, 16, v97
    v_and_b32 v29, s9, v97
    v_lshlrev_b32 v30, 16, v98
    v_and_b32 v31, s9, v98
    v_lshlrev_b32 v32, 16, v99
    v_and_b32 v33, s9, v99
    v_mul_f32 v42, v26, v10
    v_fmac_f32 v42, v27, v11
    v_fmac_f32 v42, v28, v12
    v_fmac_f32 v42, v29, v13
    v_fmac_f32 v42, v30, v14
    v_fmac_f32 v42, v31, v15
    v_fmac_f32 v42, v32, v16
    v_fmac_f32 v42, v33, v17
    s_waitcnt vmcnt(2)
    buffer_load_dwordx4 v[112:115], v2, s[40:43], s47 offen offset:0 nt
    v_lshlrev_b32 v26, 16, v100
    v_and_b32 v27, s9, v100
    v_lshlrev_b32 v28, 16, v101
    v_and_b32 v29, s9, v101
    v_lshlrev_b32 v30, 16, v102
    v_and_b32 v31, s9, v102
    v_lshlrev_b32 v32, 16, v103
    v_and_b32 v33, s9, v103
    v_mul_f32 v43, v26, v10
    v_fmac_f32 v43, v27, v11
    v_fmac_f32 v43, v28, v12
    v_fmac_f32 v43, v29, v13
    v_fmac_f32 v43, v30, v14
    v_fmac_f32 v43, v31, v15
    v_fmac_f32 v43, v32, v16
    v_fmac_f32 v43, v33, v17
    s_waitcnt vmcnt(2)
    buffer_load_dwordx4 v[116:119], v2, s[40:43], s47 offen offset:1024 nt
    v_lshlrev_b32 v26, 16, v104
    v_and_b32 v27, s9, v104
    v_lshlrev_b32 v28, 16, v105
    v_and_b32 v29, s9, v105
    v_lshlrev_b32 v30, 16, v106
    v_and_b32 v31, s9, v106
    v_lshlrev_b32 v32, 16, v107
    v_and_b32 v33, s9, v107
    v_mul_f32 v44, v26, v10
    v_fmac_f32 v44, v27, v11
    v_fmac_f32 v44, v28, v12
    v_fmac_f32 v44, v29, v13
    v_fmac_f32 v44, v30, v14
    v_fmac_f32 v44, v31, v15
    v_fmac_f32 v44, v32, v16
    v_fmac_f32 v44, v33, v17
    s_waitcnt vmcnt(2)
    v_lshlrev_b32 v26, 16, v108
    v_and_b32 v27, s9, v108
    v_lshlrev_b32 v28, 16, v109
    v_and_b32 v29, s9, v109
    v_lshlrev_b32 v30, 16, v110
    v_and_b32 v31, s9, v110
    v_lshlrev_b32 v32, 16, v111
    v_and_b32 v33, s9, v111
    v_mul_f32 v45, v26, v10
    v_fmac_f32 v45, v27, v11
    v_fmac_f32 v45, v28, v12
    v_fmac_f32 v45, v29, v13
    v_fmac_f32 v45, v30, v14
    v_fmac_f32 v45, v31, v15
    v_fmac_f32 v45, v32, v16
    v_fmac_f32 v45, v33, v17
    s_waitcnt vmcnt(1)
    buffer_load_dwordx4 v[120:123], v2, s[40:43], s47 offen offset:2048 nt
    buffer_load_dwordx4 v[124:127], v2, s[40:43], s47 offen offset:3072 nt
    s_add_u32 s44, s44, s8
    s_add_u32 s45, s44, 262144
    s_add_u32 s46, s44, 524288
    s_add_u32 s47, s44, 786432
    s_cmp_lg_u32 s6, 7
    s_cbranch_scc1 L_KNOSWE
    s_mov_b32 s40, s20
    s_mov_b32 s41, s21
    s_mov_b32 s44, s52
    s_add_u32 s45, s44, 262144
    s_add_u32 s46, s44, 524288
    s_add_u32 s47, s44, 786432
L_KNOSWE:
    v_lshlrev_b32 v26, 16, v112
    v_and_b32 v27, s9, v112
    v_lshlrev_b32 v28, 16, v113
    v_and_b32 v29, s9, v113
    v_lshlrev_b32 v30, 16, v114
    v_and_b32 v31, s9, v114
    v_lshlrev_b32 v32, 16, v115
    v_and_b32 v33, s9, v115
    v_mul_f32 v46, v26, v10
    v_fmac_f32 v46, v27, v11
    v_fmac_f32 v46, v28, v12
    v_fmac_f32 v46, v29, v13
    v_fmac_f32 v46, v30, v14
    v_fmac_f32 v46, v31, v15
    v_fmac_f32 v46, v32, v16
    v_fmac_f32 v46, v33, v17
    s_waitcnt vmcnt(2)
    buffer_load_dwordx4 v[64:67], v2, s[40:43], s44 offen offset:0 nt
    v_lshlrev_b32 v26, 16, v116
    v_and_b32 v27, s9, v116
    v_lshlrev_b32 v28, 16, v117
    v_and_b32 v29, s9, v117
    v_lshlrev_b32 v30, 16, v118
    v_and_b32 v31, s9, v118
    v_lshlrev_b32 v32, 16, v119
    v_and_b32 v33, s9, v119
    v_mul_f32 v47, v26, v10
    v_fmac_f32 v47, v27, v11
    v_fmac_f32 v47, v28, v12
    v_fmac_f32 v47, v29, v13
    v_fmac_f32 v47, v30, v14
    v_fmac_f32 v47, v31, v15
    v_fmac_f32 v47, v32, v16
    v_fmac_f32 v47, v33, v17
    s_waitcnt vmcnt(2)
    buffer_load_dwordx4 v[68:71], v2, s[40:43], s44 offen offset:1024 nt
    v_lshlrev_b32 v26, 16, v120
    v_and_b32 v27, s9, v120
    v_lshlrev_b32 v28, 16, v121
    v_and_b32 v29, s9, v121
    v_lshlrev_b32 v30, 16, v122
    v_and_b32 v31, s9, v122
    v_lshlrev_b32 v32, 16, v123
    v_and_b32 v33, s9, v123
    v_mul_f32 v48, v26, v10
    v_fmac_f32 v48, v27, v11
    v_fmac_f32 v48, v28, v12
    v_fmac_f32 v48, v29, v13
    v_fmac_f32 v48, v30, v14
    v_fmac_f32 v48, v31, v15
    v_fmac_f32 v48, v32, v16
    v_fmac_f32 v48, v33, v17
    s_waitcnt vmcnt(2)
    v_lshlrev_b32 v26, 16, v124
    v_and_b32 v27, s9, v124
    v_lshlrev_b32 v28, 16, v125
    v_and_b32 v29, s9, v125
    v_lshlrev_b32 v30, 16, v126
    v_and_b32 v31, s9, v126
    v_lshlrev_b32 v32, 16, v127
    v_and_b32 v33, s9, v127
    v_mul_f32 v49, v26, v10
    v_fmac_f32 v49, v27, v11
    v_fmac_f32 v49, v28, v12
    v_fmac_f32 v49, v29, v13
    v_fmac_f32 v49, v30, v14
    v_fmac_f32 v49, v31, v15
    v_fmac_f32 v49, v32, v16
    v_fmac_f32 v49, v33, v17
    s_cmp_lg_u32 s6, 7
    s_cbranch_scc1 L_KNOXE
    buffer_load_dwordx4 v[72:75], v2, s[40:43], s44 offen offset:2048 nt
    buffer_load_dwordx4 v[76:79], v2, s[40:43], s44 offen offset:3072 nt
    buffer_load_dwordx4 v[80:83], v2, s[40:43], s45 offen offset:0 nt
    buffer_load_dwordx4 v[84:87], v2, s[40:43], s45 offen offset:1024 nt
L_KNOXE:
    s_nop 0
    v_add_f32_dpp v34, v34, v34 row_mirror row_mask:0xf bank_mask:0x3
    v_add_f32_dpp v34, v42, v42 row_mirror row_mask:0xf bank_mask:0xc
    v_add_f32_dpp v35, v35, v35 row_mirror row_mask:0xf bank_mask:0x3
    v_add_f32_dpp v35, v43, v43 row_mirror row_mask:0xf bank_mask:0xc
    v_add_f32_dpp v36, v36, v36 row_mirror row_mask:0xf bank_mask:0x3
    v_add_f32_dpp v36, v44, v44 row_mirror row_mask:0xf bank_mask:0xc
    v_add_f32_dpp v37, v37, v37 row_mirror row_mask:0xf bank_mask:0x3
    v_add_f32_dpp v37, v45, v45 row_mirror row_mask:0xf bank_mask:0xc
    v_add_f32_dpp v38, v38, v38 row_mirror row_mask:0xf bank_mask:0x3
    v_add_f32_dpp v38, v46, v46 row_mirror row_mask:0xf bank_mask:0xc
    v_add_f32_dpp v39, v39, v39 row_mirror row_mask:0xf bank_mask:0x3
    v_add_f32_dpp v39, v47, v47 row_mirror row_mask:0xf bank_mask:0xc
    v_add_f32_dpp v40, v40, v40 row_mirror row_mask:0xf bank_mask:0x3
    v_add_f32_dpp v40, v48, v48 row_mirror row_mask:0xf bank_mask:0xc
    v_add_f32_dpp v41, v41, v41 row_mirror row_mask:0xf bank_mask:0x3
    v_add_f32_dpp v41, v49, v49 row_mirror row_mask:0xf bank_mask:0xc
    s_nop 0
    v_add_f32_dpp v34, v34, v34 row_half_mirror row_mask:0xf bank_mask:0x5
    v_add_f32_dpp v34, v38, v38 row_half_mirror row_mask:0xf bank_mask:0xa
    v_add_f32_dpp v35, v35, v35 row_half_mirror row_mask:0xf bank_mask:0x5
    v_add_f32_dpp v35, v39, v39 row_half_mirror row_mask:0xf bank_mask:0xa
    v_add_f32_dpp v36, v36, v36 row_half_mirror row_mask:0xf bank_mask:0x5
    v_add_f32_dpp v36, v40, v40 row_half_mirror row_mask:0xf bank_mask:0xa
    v_add_f32_dpp v37, v37, v37 row_half_mirror row_mask:0xf bank_mask:0x5
    v_add_f32_dpp v37, v41, v41 row_half_mirror row_mask:0xf bank_mask:0xa
    s_nop 1
    v_add_f32_dpp v42, v34, v34 quad_perm:[3,2,1,0] row_mask:0xf bank_mask:0xf
    v_add_f32_dpp v43, v35, v35 quad_perm:[3,2,1,0] row_mask:0xf bank_mask:0xf
    v_add_f32_dpp v44, v36, v36 quad_perm:[3,2,1,0] row_mask:0xf bank_mask:0xf
    v_add_f32_dpp v45, v37, v37 quad_perm:[3,2,1,0] row_mask:0xf bank_mask:0xf
    s_nop 0
    v_cndmask_b32 v34, v42, v44, s[50:51]
    v_cndmask_b32 v35, v43, v45, s[50:51]
    s_nop 1
    v_add_f32_dpp v42, v34, v34 quad_perm:[1,0,3,2] row_mask:0xf bank_mask:0xf
    v_add_f32_dpp v43, v35, v35 quad_perm:[1,0,3,2] row_mask:0xf bank_mask:0xf
    s_nop 0
    v_cndmask_b32 v34, v42, v43, s[48:49]
    s_nop 0
    ds_write_b32 v6, v34 offset:8192
    v_max_f32 v7, v7, v34
    v_add_u32 v6, 256, v6
    s_add_u32 s6, s6, 1
    s_cmp_lt_u32 s6, 8
    s_cbranch_scc1 L_KLOOPE
    v_subrev_u32 v6, 2048, v6
    s_waitcnt lgkmcnt(0)
    ds_read_b32 v34, v6 offset:8192
    ds_read_b32 v35, v6 offset:8448
    ds_read_b32 v36, v6 offset:8704
    ds_read_b32 v37, v6 offset:8960
    ds_read_b32 v38, v6 offset:9216
    ds_read_b32 v39, v6 offset:9472
    ds_read_b32 v40, v6 offset:9728
    ds_read_b32 v41, v6 offset:9984
    s_nop 1
    v_max_f32_dpp v7, v7, v7 row_ror:8 row_mask:0xf bank_mask:0xf
    s_nop 1
    v_max_f32_dpp v7, v7, v7 row_ror:4 row_mask:0xf bank_mask:0xf
    s_nop 1
    v_max_f32_dpp v7, v7, v7 row_ror:2 row_mask:0xf bank_mask:0xf
    s_nop 1
    v_max_f32_dpp v7, v7, v7 row_ror:1 row_mask:0xf bank_mask:0xf
    s_nop 0
    v_readlane_b32 s60, v7, 0
    v_readlane_b32 s61, v7, 16
    v_readlane_b32 s62, v7, 32
    v_readlane_b32 s63, v7, 48
    s_nop 1
    v_mov_b32 v7, s60
    v_max_f32 v7, s61, v7
    v_max_f32 v7, s62, v7
    v_max_f32 v7, s63, v7
    v_mov_b32 v18, 0
    v_mov_b32 v19, 0
    v_mov_b32 v20, 0
    v_mov_b32 v21, 0
    v_mov_b32 v22, 0
    v_mov_b32 v23, 0
    v_mov_b32 v24, 0
    v_mov_b32 v25, 0
    s_waitcnt lgkmcnt(0)
    v_sub_f32 v34, v34, v7
    v_exp_f32 v8, v34
    s_nop 0
    s_waitcnt vmcnt(5)
    v_lshlrev_b32 v26, 16, v64
    v_and_b32 v27, s9, v64
    v_lshlrev_b32 v28, 16, v65
    v_and_b32 v29, s9, v65
    v_lshlrev_b32 v30, 16, v66
    v_and_b32 v31, s9, v66
    v_lshlrev_b32 v32, 16, v67
    v_and_b32 v33, s9, v67
    v_fmac_f32_dpp v18, v8, v26 row_newbcast:0 row_mask:0xf bank_mask:0xf
    v_fmac_f32_dpp v19, v8, v27 row_newbcast:0 row_mask:0xf bank_mask:0xf
    v_fmac_f32_dpp v20, v8, v28 row_newbcast:0 row_mask:0xf bank_mask:0xf
    v_fmac_f32_dpp v21, v8, v29 row_newbcast:0 row_mask:0xf bank_mask:0xf
    v_fmac_f32_dpp v22, v8, v30 row_newbcast:0 row_mask:0xf bank_mask:0xf
    v_fmac_f32_dpp v23, v8, v31 row_newbcast:0 row_mask:0xf bank_mask:0xf
    v_fmac_f32_dpp v24, v8, v32 row_newbcast:0 row_mask:0xf bank_mask:0xf
    v_fmac_f32_dpp v25, v8, v33 row_newbcast:0 row_mask:0xf bank_mask:0xf
    v_sub_f32 v35, v35, v7
    v_sub_f32 v36, v36, v7
    v_sub_f32 v37, v37, v7
    v_sub_f32 v38, v38, v7
    v_exp_f32 v35, v35
    v_exp_f32 v36, v36
    v_exp_f32 v37, v37
    v_exp_f32 v38, v38
    s_waitcnt vmcnt(4)
    v_lshlrev_b32 v26, 16, v68
    v_and_b32 v27, s9, v68
    v_lshlrev_b32 v28, 16, v69
    v_and_b32 v29, s9, v69
    v_lshlrev_b32 v30, 16, v70
    v_and_b32 v31, s9, v70
    v_lshlrev_b32 v32, 16, v71
    v_and_b32 v33, s9, v71
    v_fmac_f32_dpp v18, v8, v26 row_newbcast:1 row_mask:0xf bank_mask:0xf
    v_fmac_f32_dpp v19, v8, v27 row_newbcast:1 row_mask:0xf bank_mask:0xf
    v_fmac_f32_dpp v20, v8, v28 row_newbcast:1 row_mask:0xf bank_mask:0xf
    v_fmac_f32_dpp v21, v8, v29 row_newbcast:1 row_mask:0xf bank_mask:0xf
    v_fmac_f32_dpp v22, v8, v30 row_newbcast:1 row_mask:0xf bank_mask:0xf
    v_fmac_f32_dpp v23, v8, v31 row_newbcast:1 row_mask:0xf bank_mask:0xf
    v_fmac_f32_dpp v24, v8, v32 row_newbcast:1 row_mask:0xf bank_mask:0xf
    v_fmac_f32_dpp v25, v8, v33 row_newbcast:1 row_mask:0xf bank_mask:0xf
    v_sub_f32 v39, v39, v7
    v_sub_f32 v40, v40, v7
    v_sub_f32 v41, v41, v7
    v_exp_f32 v39, v39
    v_exp_f32 v40, v40
    v_exp_f32 v41, v41
    s_waitcnt vmcnt(3)
    v_lshlrev_b32 v26, 16, v72
    v_and_b32 v27, s9, v72
    v_lshlrev_b32 v28, 16, v73
    v_and_b32 v29, s9, v73
    v_lshlrev_b32 v30, 16, v74
    v_and_b32 v31, s9, v74
    v_lshlrev_b32 v32, 16, v75
    v_and_b32 v33, s9, v75
    v_fmac_f32_dpp v18, v8, v26 row_newbcast:2 row_mask:0xf bank_mask:0xf
    v_fmac_f32_dpp v19, v8, v27 row_newbcast:2 row_mask:0xf bank_mask:0xf
    v_fmac_f32_dpp v20, v8, v28 row_newbcast:2 row_mask:0xf bank_mask:0xf
    v_fmac_f32_dpp v21, v8, v29 row_newbcast:2 row_mask:0xf bank_mask:0xf
    v_fmac_f32_dpp v22, v8, v30 row_newbcast:2 row_mask:0xf bank_mask:0xf
    v_fmac_f32_dpp v23, v8, v31 row_newbcast:2 row_mask:0xf bank_mask:0xf
    v_fmac_f32_dpp v24, v8, v32 row_newbcast:2 row_mask:0xf bank_mask:0xf
    v_fmac_f32_dpp v25, v8, v33 row_newbcast:2 row_mask:0xf bank_mask:0xf
    ds_write_b32 v6, v35 offset:8448
    ds_write_b32 v6, v36 offset:8704
    ds_write_b32 v6, v37 offset:8960
    ds_write_b32 v6, v38 offset:9216
    ds_write_b32 v6, v39 offset:9472
    ds_write_b32 v6, v40 offset:9728
    ds_write_b32 v6, v41 offset:9984
    ds_write_b32 v6, v8 offset:8192
    v_mov_b32 v9, v35
    s_waitcnt vmcnt(2)
    v_lshlrev_b32 v26, 16, v76
    v_and_b32 v27, s9, v76
    v_lshlrev_b32 v28, 16, v77
    v_and_b32 v29, s9, v77
    v_lshlrev_b32 v30, 16, v78
    v_and_b32 v31, s9, v78
    v_lshlrev_b32 v32, 16, v79
    v_and_b32 v33, s9, v79
    v_fmac_f32_dpp v18, v8, v26 row_newbcast:3 row_mask:0xf bank_mask:0xf
    v_fmac_f32_dpp v19, v8, v27 row_newbcast:3 row_mask:0xf bank_mask:0xf
    v_fmac_f32_dpp v20, v8, v28 row_newbcast:3 row_mask:0xf bank_mask:0xf
    v_fmac_f32_dpp v21, v8, v29 row_newbcast:3 row_mask:0xf bank_mask:0xf
    v_fmac_f32_dpp v22, v8, v30 row_newbcast:3 row_mask:0xf bank_mask:0xf
    v_fmac_f32_dpp v23, v8, v31 row_newbcast:3 row_mask:0xf bank_mask:0xf
    v_fmac_f32_dpp v24, v8, v32 row_newbcast:3 row_mask:0xf bank_mask:0xf
    v_fmac_f32_dpp v25, v8, v33 row_newbcast:3 row_mask:0xf bank_mask:0xf
    v_add_f32 v56, v8, v35
    v_add_f32 v56, v56, v36
    v_add_f32 v56, v56, v37
    v_add_f32 v56, v56, v38
    v_add_f32 v56, v56, v39
    v_add_f32 v56, v56, v40
    v_add_f32 v56, v56, v41
    s_waitcnt vmcnt(1)
    buffer_load_dwordx4 v[88:91], v2, s[40:43], s45 offen offset:2048 nt
    buffer_load_dwordx4 v[92:95], v2, s[40:43], s45 offen offset:3072 nt
    v_lshlrev_b32 v26, 16, v80
    v_and_b32 v27, s9, v80
    v_lshlrev_b32 v28, 16, v81
    v_and_b32 v29, s9, v81
    v_lshlrev_b32 v30, 16, v82
    v_and_b32 v31, s9, v82
    v_lshlrev_b32 v32, 16, v83
    v_and_b32 v33, s9, v83
    v_fmac_f32_dpp v18, v8, v26 row_newbcast:4 row_mask:0xf bank_mask:0xf
    v_fmac_f32_dpp v19, v8, v27 row_newbcast:4 row_mask:0xf bank_mask:0xf
    v_fmac_f32_dpp v20, v8, v28 row_newbcast:4 row_mask:0xf bank_mask:0xf
    v_fmac_f32_dpp v21, v8, v29 row_newbcast:4 row_mask:0xf bank_mask:0xf
    v_fmac_f32_dpp v22, v8, v30 row_newbcast:4 row_mask:0xf bank_mask:0xf
    v_fmac_f32_dpp v23, v8, v31 row_newbcast:4 row_mask:0xf bank_mask:0xf
    v_fmac_f32_dpp v24, v8, v32 row_newbcast:4 row_mask:0xf bank_mask:0xf
    v_fmac_f32_dpp v25, v8, v33 row_newbcast:4 row_mask:0xf bank_mask:0xf
    s_nop 1
    v_add_f32_dpp v56, v56, v56 row_ror:8 row_mask:0xf bank_mask:0xf
    s_nop 1
    v_add_f32_dpp v56, v56, v56 row_ror:4 row_mask:0xf bank_mask:0xf
    s_nop 1
    v_add_f32_dpp v56, v56, v56 row_ror:2 row_mask:0xf bank_mask:0xf
    s_nop 1
    v_add_f32_dpp v56, v56, v56 row_ror:1 row_mask:0xf bank_mask:0xf
    s_nop 0
    v_readlane_b32 s60, v56, 0
    v_readlane_b32 s61, v56, 16
    v_readlane_b32 s62, v56, 32
    v_readlane_b32 s63, v56, 48
    s_nop 1
    v_mov_b32 v56, s60
    v_add_f32 v56, s61, v56
    v_add_f32 v56, s62, v56
    v_add_f32 v56, s63, v56
    s_waitcnt vmcnt(2)
    buffer_load_dwordx4 v[96:99], v2, s[40:43], s46 offen offset:0 nt
    v_lshlrev_b32 v26, 16, v84
    v_and_b32 v27, s9, v84
    v_lshlrev_b32 v28, 16, v85
    v_and_b32 v29, s9, v85
    v_lshlrev_b32 v30, 16, v86
    v_and_b32 v31, s9, v86
    v_lshlrev_b32 v32, 16, v87
    v_and_b32 v33, s9, v87
    v_fmac_f32_dpp v18, v8, v26 row_newbcast:5 row_mask:0xf bank_mask:0xf
    v_fmac_f32_dpp v19, v8, v27 row_newbcast:5 row_mask:0xf bank_mask:0xf
    v_fmac_f32_dpp v20, v8, v28 row_newbcast:5 row_mask:0xf bank_mask:0xf
    v_fmac_f32_dpp v21, v8, v29 row_newbcast:5 row_mask:0xf bank_mask:0xf
    v_fmac_f32_dpp v22, v8, v30 row_newbcast:5 row_mask:0xf bank_mask:0xf
    v_fmac_f32_dpp v23, v8, v31 row_newbcast:5 row_mask:0xf bank_mask:0xf
    v_fmac_f32_dpp v24, v8, v32 row_newbcast:5 row_mask:0xf bank_mask:0xf
    v_fmac_f32_dpp v25, v8, v33 row_newbcast:5 row_mask:0xf bank_mask:0xf
    v_mov_b32 v52, v7
    v_mov_b32 v53, v56
    s_lshl_b32 s61, s5, 3
    v_mov_b32 v3, s61
    s_mov_b64 exec, 1
    ds_write_b64 v3, v[52:53] offset:1088
    s_mov_b64 exec, -1
    s_waitcnt vmcnt(2)
    buffer_load_dwordx4 v[100:103], v2, s[40:43], s46 offen offset:1024 nt
    v_lshlrev_b32 v26, 16, v88
    v_and_b32 v27, s9, v88
    v_lshlrev_b32 v28, 16, v89
    v_and_b32 v29, s9, v89
    v_lshlrev_b32 v30, 16, v90
    v_and_b32 v31, s9, v90
    v_lshlrev_b32 v32, 16, v91
    v_and_b32 v33, s9, v91
    v_fmac_f32_dpp v18, v8, v26 row_newbcast:6 row_mask:0xf bank_mask:0xf
    v_fmac_f32_dpp v19, v8, v27 row_newbcast:6 row_mask:0xf bank_mask:0xf
    v_fmac_f32_dpp v20, v8, v28 row_newbcast:6 row_mask:0xf bank_mask:0xf
    v_fmac_f32_dpp v21, v8, v29 row_newbcast:6 row_mask:0xf bank_mask:0xf
    v_fmac_f32_dpp v22, v8, v30 row_newbcast:6 row_mask:0xf bank_mask:0xf
    v_fmac_f32_dpp v23, v8, v31 row_newbcast:6 row_mask:0xf bank_mask:0xf
    v_fmac_f32_dpp v24, v8, v32 row_newbcast:6 row_mask:0xf bank_mask:0xf
    v_fmac_f32_dpp v25, v8, v33 row_newbcast:6 row_mask:0xf bank_mask:0xf
    s_waitcnt lgkmcnt(0)
    v_mov_b32 v4, 1
    s_mov_b64 exec, 1
    ds_add_u32 v5, v4 offset:1052
    s_mov_b64 exec, -1
    s_waitcnt vmcnt(2)
    v_lshlrev_b32 v26, 16, v92
    v_and_b32 v27, s9, v92
    v_lshlrev_b32 v28, 16, v93
    v_and_b32 v29, s9, v93
    v_lshlrev_b32 v30, 16, v94
    v_and_b32 v31, s9, v94
    v_lshlrev_b32 v32, 16, v95
    v_and_b32 v33, s9, v95
    v_fmac_f32_dpp v18, v8, v26 row_newbcast:7 row_mask:0xf bank_mask:0xf
    v_fmac_f32_dpp v19, v8, v27 row_newbcast:7 row_mask:0xf bank_mask:0xf
    v_fmac_f32_dpp v20, v8, v28 row_newbcast:7 row_mask:0xf bank_mask:0xf
    v_fmac_f32_dpp v21, v8, v29 row_newbcast:7 row_mask:0xf bank_mask:0xf
    v_fmac_f32_dpp v22, v8, v30 row_newbcast:7 row_mask:0xf bank_mask:0xf
    v_fmac_f32_dpp v23, v8, v31 row_newbcast:7 row_mask:0xf bank_mask:0xf
    v_fmac_f32_dpp v24, v8, v32 row_newbcast:7 row_mask:0xf bank_mask:0xf
    v_fmac_f32_dpp v25, v8, v33 row_newbcast:7 row_mask:0xf bank_mask:0xf
    s_waitcnt vmcnt(1)
    buffer_load_dwordx4 v[104:107], v2, s[40:43], s46 offen offset:2048 nt
    buffer_load_dwordx4 v[108:111], v2, s[40:43], s46 offen offset:3072 nt
    v_lshlrev_b32 v26, 16, v96
    v_and_b32 v27, s9, v96
    v_lshlrev_b32 v28, 16, v97
    v_and_b32 v29, s9, v97
    v_lshlrev_b32 v30, 16, v98
    v_and_b32 v31, s9, v98
    v_lshlrev_b32 v32, 16, v99
    v_and_b32 v33, s9, v99
    v_fmac_f32_dpp v18, v8, v26 row_newbcast:8 row_mask:0xf bank_mask:0xf
    v_fmac_f32_dpp v19, v8, v27 row_newbcast:8 row_mask:0xf bank_mask:0xf
    v_fmac_f32_dpp v20, v8, v28 row_newbcast:8 row_mask:0xf bank_mask:0xf
    v_fmac_f32_dpp v21, v8, v29 row_newbcast:8 row_mask:0xf bank_mask:0xf
    v_fmac_f32_dpp v22, v8, v30 row_newbcast:8 row_mask:0xf bank_mask:0xf
    v_fmac_f32_dpp v23, v8, v31 row_newbcast:8 row_mask:0xf bank_mask:0xf
    v_fmac_f32_dpp v24, v8, v32 row_newbcast:8 row_mask:0xf bank_mask:0xf
    v_fmac_f32_dpp v25, v8, v33 row_newbcast:8 row_mask:0xf bank_mask:0xf
    s_waitcnt vmcnt(2)
    buffer_load_dwordx4 v[112:115], v2, s[40:43], s47 offen offset:0 nt
    v_lshlrev_b32 v26, 16, v100
    v_and_b32 v27, s9, v100
    v_lshlrev_b32 v28, 16, v101
    v_and_b32 v29, s9, v101
    v_lshlrev_b32 v30, 16, v102
    v_and_b32 v31, s9, v102
    v_lshlrev_b32 v32, 16, v103
    v_and_b32 v33, s9, v103
    v_fmac_f32_dpp v18, v8, v26 row_newbcast:9 row_mask:0xf bank_mask:0xf
    v_fmac_f32_dpp v19, v8, v27 row_newbcast:9 row_mask:0xf bank_mask:0xf
    v_fmac_f32_dpp v20, v8, v28 row_newbcast:9 row_mask:0xf bank_mask:0xf
    v_fmac_f32_dpp v21, v8, v29 row_newbcast:9 row_mask:0xf bank_mask:0xf
    v_fmac_f32_dpp v22, v8, v30 row_newbcast:9 row_mask:0xf bank_mask:0xf
    v_fmac_f32_dpp v23, v8, v31 row_newbcast:9 row_mask:0xf bank_mask:0xf
    v_fmac_f32_dpp v24, v8, v32 row_newbcast:9 row_mask:0xf bank_mask:0xf
    v_fmac_f32_dpp v25, v8, v33 row_newbcast:9 row_mask:0xf bank_mask:0xf
    s_waitcnt vmcnt(2)
    buffer_load_dwordx4 v[116:119], v2, s[40:43], s47 offen offset:1024 nt
    v_lshlrev_b32 v26, 16, v104
    v_and_b32 v27, s9, v104
    v_lshlrev_b32 v28, 16, v105
    v_and_b32 v29, s9, v105
    v_lshlrev_b32 v30, 16, v106
    v_and_b32 v31, s9, v106
    v_lshlrev_b32 v32, 16, v107
    v_and_b32 v33, s9, v107
    v_fmac_f32_dpp v18, v8, v26 row_newbcast:10 row_mask:0xf bank_mask:0xf
    v_fmac_f32_dpp v19, v8, v27 row_newbcast:10 row_mask:0xf bank_mask:0xf
    v_fmac_f32_dpp v20, v8, v28 row_newbcast:10 row_mask:0xf bank_mask:0xf
    v_fmac_f32_dpp v21, v8, v29 row_newbcast:10 row_mask:0xf bank_mask:0xf
    v_fmac_f32_dpp v22, v8, v30 row_newbcast:10 row_mask:0xf bank_mask:0xf
    v_fmac_f32_dpp v23, v8, v31 row_newbcast:10 row_mask:0xf bank_mask:0xf
    v_fmac_f32_dpp v24, v8, v32 row_newbcast:10 row_mask:0xf bank_mask:0xf
    v_fmac_f32_dpp v25, v8, v33 row_newbcast:10 row_mask:0xf bank_mask:0xf
    s_waitcnt vmcnt(2)
    v_lshlrev_b32 v26, 16, v108
    v_and_b32 v27, s9, v108
    v_lshlrev_b32 v28, 16, v109
    v_and_b32 v29, s9, v109
    v_lshlrev_b32 v30, 16, v110
    v_and_b32 v31, s9, v110
    v_lshlrev_b32 v32, 16, v111
    v_and_b32 v33, s9, v111
    v_fmac_f32_dpp v18, v8, v26 row_newbcast:11 row_mask:0xf bank_mask:0xf
    v_fmac_f32_dpp v19, v8, v27 row_newbcast:11 row_mask:0xf bank_mask:0xf
    v_fmac_f32_dpp v20, v8, v28 row_newbcast:11 row_mask:0xf bank_mask:0xf
    v_fmac_f32_dpp v21, v8, v29 row_newbcast:11 row_mask:0xf bank_mask:0xf
    v_fmac_f32_dpp v22, v8, v30 row_newbcast:11 row_mask:0xf bank_mask:0xf
    v_fmac_f32_dpp v23, v8, v31 row_newbcast:11 row_mask:0xf bank_mask:0xf
    v_fmac_f32_dpp v24, v8, v32 row_newbcast:11 row_mask:0xf bank_mask:0xf
    v_fmac_f32_dpp v25, v8, v33 row_newbcast:11 row_mask:0xf bank_mask:0xf
    s_waitcnt vmcnt(1)
    buffer_load_dwordx4 v[120:123], v2, s[40:43], s47 offen offset:2048 nt
    buffer_load_dwordx4 v[124:127], v2, s[40:43], s47 offen offset:3072 nt
    s_add_u32 s44, s44, s8
    s_add_u32 s45, s44, 262144
    s_add_u32 s46, s44, 524288
    s_add_u32 s47, s44, 786432
    v_lshlrev_b32 v26, 16, v112
    v_and_b32 v27, s9, v112
    v_lshlrev_b32 v28, 16, v113
    v_and_b32 v29, s9, v113
    v_lshlrev_b32 v30, 16, v114
    v_and_b32 v31, s9, v114
    v_lshlrev_b32 v32, 16, v115
    v_and_b32 v33, s9, v115
    v_fmac_f32_dpp v18, v8, v26 row_newbcast:12 row_mask:0xf bank_mask:0xf
    v_fmac_f32_dpp v19, v8, v27 row_newbcast:12 row_mask:0xf bank_mask:0xf
    v_fmac_f32_dpp v20, v8, v28 row_newbcast:12 row_mask:0xf bank_mask:0xf
    v_fmac_f32_dpp v21, v8, v29 row_newbcast:12 row_mask:0xf bank_mask:0xf
    v_fmac_f32_dpp v22, v8, v30 row_newbcast:12 row_mask:0xf bank_mask:0xf
    v_fmac_f32_dpp v23, v8, v31 row_newbcast:12 row_mask:0xf bank_mask:0xf
    v_fmac_f32_dpp v24, v8, v32 row_newbcast:12 row_mask:0xf bank_mask:0xf
    v_fmac_f32_dpp v25, v8, v33 row_newbcast:12 row_mask:0xf bank_mask:0xf
    s_waitcnt vmcnt(2)
    buffer_load_dwordx4 v[64:67], v2, s[40:43], s44 offen offset:0 nt
    v_lshlrev_b32 v26, 16, v116
    v_and_b32 v27, s9, v116
    v_lshlrev_b32 v28, 16, v117
    v_and_b32 v29, s9, v117
    v_lshlrev_b32 v30, 16, v118
    v_and_b32 v31, s9, v118
    v_lshlrev_b32 v32, 16, v119
    v_and_b32 v33, s9, v119
    v_fmac_f32_dpp v18, v8, v26 row_newbcast:13 row_mask:0xf bank_mask:0xf
    v_fmac_f32_dpp v19, v8, v27 row_newbcast:13 row_mask:0xf bank_mask:0xf
    v_fmac_f32_dpp v20, v8, v28 row_newbcast:13 row_mask:0xf bank_mask:0xf
    v_fmac_f32_dpp v21, v8, v29 row_newbcast:13 row_mask:0xf bank_mask:0xf
    v_fmac_f32_dpp v22, v8, v30 row_newbcast:13 row_mask:0xf bank_mask:0xf
    v_fmac_f32_dpp v23, v8, v31 row_newbcast:13 row_mask:0xf bank_mask:0xf
    v_fmac_f32_dpp v24, v8, v32 row_newbcast:13 row_mask:0xf bank_mask:0xf
    v_fmac_f32_dpp v25, v8, v33 row_newbcast:13 row_mask:0xf bank_mask:0xf
    s_waitcnt vmcnt(2)
    buffer_load_dwordx4 v[68:71], v2, s[40:43], s44 offen offset:1024 nt
    v_lshlrev_b32 v26, 16, v120
    v_and_b32 v27, s9, v120
    v_lshlrev_b32 v28, 16, v121
    v_and_b32 v29, s9, v121
    v_lshlrev_b32 v30, 16, v122
    v_and_b32 v31, s9, v122
    v_lshlrev_b32 v32, 16, v123
    v_and_b32 v33, s9, v123
    v_fmac_f32_dpp v18, v8, v26 row_newbcast:14 row_mask:0xf bank_mask:0xf
    v_fmac_f32_dpp v19, v8, v27 row_newbcast:14 row_mask:0xf bank_mask:0xf
    v_fmac_f32_dpp v20, v8, v28 row_newbcast:14 row_mask:0xf bank_mask:0xf
    v_fmac_f32_dpp v21, v8, v29 row_newbcast:14 row_mask:0xf bank_mask:0xf
    v_fmac_f32_dpp v22, v8, v30 row_newbcast:14 row_mask:0xf bank_mask:0xf
    v_fmac_f32_dpp v23, v8, v31 row_newbcast:14 row_mask:0xf bank_mask:0xf
    v_fmac_f32_dpp v24, v8, v32 row_newbcast:14 row_mask:0xf bank_mask:0xf
    v_fmac_f32_dpp v25, v8, v33 row_newbcast:14 row_mask:0xf bank_mask:0xf
    s_waitcnt vmcnt(2)
    v_lshlrev_b32 v26, 16, v124
    v_and_b32 v27, s9, v124
    v_lshlrev_b32 v28, 16, v125
    v_and_b32 v29, s9, v125
    v_lshlrev_b32 v30, 16, v126
    v_and_b32 v31, s9, v126
    v_lshlrev_b32 v32, 16, v127
    v_and_b32 v33, s9, v127
    v_fmac_f32_dpp v18, v8, v26 row_newbcast:15 row_mask:0xf bank_mask:0xf
    v_fmac_f32_dpp v19, v8, v27 row_newbcast:15 row_mask:0xf bank_mask:0xf
    v_fmac_f32_dpp v20, v8, v28 row_newbcast:15 row_mask:0xf bank_mask:0xf
    v_fmac_f32_dpp v21, v8, v29 row_newbcast:15 row_mask:0xf bank_mask:0xf
    v_fmac_f32_dpp v22, v8, v30 row_newbcast:15 row_mask:0xf bank_mask:0xf
    v_fmac_f32_dpp v23, v8, v31 row_newbcast:15 row_mask:0xf bank_mask:0xf
    v_fmac_f32_dpp v24, v8, v32 row_newbcast:15 row_mask:0xf bank_mask:0xf
    v_fmac_f32_dpp v25, v8, v33 row_newbcast:15 row_mask:0xf bank_mask:0xf
    v_add_u32 v6, 512, v6
    s_mov_b32 s6, 1
L_VLOOPE:
    s_waitcnt lgkmcnt(0)
    v_mov_b32 v8, v9
    ds_read_b32 v9, v6 offset:8192
    v_add_u32 v6, 256, v6
    s_waitcnt vmcnt(1)
    buffer_load_dwordx4 v[72:75], v2, s[40:43], s44 offen offset:2048 nt
    buffer_load_dwordx4 v[76:79], v2, s[40:43], s44 offen offset:3072 nt
    v_lshlrev_b32 v26, 16, v64
    v_and_b32 v27, s9, v64
    v_lshlrev_b32 v28, 16, v65
    v_and_b32 v29, s9, v65
    v_lshlrev_b32 v30, 16, v66
    v_and_b32 v31, s9, v66
    v_lshlrev_b32 v32, 16, v67
    v_and_b32 v33, s9, v67
    v_fmac_f32_dpp v18, v8, v26 row_newbcast:0 row_mask:0xf bank_mask:0xf
    v_fmac_f32_dpp v19, v8, v27 row_newbcast:0 row_mask:0xf bank_mask:0xf
    v_fmac_f32_dpp v20, v8, v28 row_newbcast:0 row_mask:0xf bank_mask:0xf
    v_fmac_f32_dpp v21, v8, v29 row_newbcast:0 row_mask:0xf bank_mask:0xf
    v_fmac_f32_dpp v22, v8, v30 row_newbcast:0 row_mask:0xf bank_mask:0xf
    v_fmac_f32_dpp v23, v8, v31 row_newbcast:0 row_mask:0xf bank_mask:0xf
    v_fmac_f32_dpp v24, v8, v32 row_newbcast:0 row_mask:0xf bank_mask:0xf
    v_fmac_f32_dpp v25, v8, v33 row_newbcast:0 row_mask:0xf bank_mask:0xf
    s_waitcnt vmcnt(2)
    buffer_load_dwordx4 v[80:83], v2, s[40:43], s45 offen offset:0 nt
    v_lshlrev_b32 v26, 16, v68
    v_and_b32 v27, s9, v68
    v_lshlrev_b32 v28, 16, v69
    v_and_b32 v29, s9, v69
    v_lshlrev_b32 v30, 16, v70
    v_and_b32 v31, s9, v70
    v_lshlrev_b32 v32, 16, v71
    v_and_b32 v33, s9, v71
    v_fmac_f32_dpp v18, v8, v26 row_newbcast:1 row_mask:0xf bank_mask:0xf
    v_fmac_f32_dpp v19, v8, v27 row_newbcast:1 row_mask:0xf bank_mask:0xf
    v_fmac_f32_dpp v20, v8, v28 row_newbcast:1 row_mask:0xf bank_mask:0xf
    v_fmac_f32_dpp v21, v8, v29 row_newbcast:1 row_mask:0xf bank_mask:0xf
    v_fmac_f32_dpp v22, v8, v30 row_newbcast:1 row_mask:0xf bank_mask:0xf
    v_fmac_f32_dpp v23, v8, v31 row_newbcast:1 row_mask:0xf bank_mask:0xf
    v_fmac_f32_dpp v24, v8, v32 row_newbcast:1 row_mask:0xf bank_mask:0xf
    v_fmac_f32_dpp v25, v8, v33 row_newbcast:1 row_mask:0xf bank_mask:0xf
    s_waitcnt vmcnt(2)
    buffer_load_dwordx4 v[84:87], v2, s[40:43], s45 offen offset:1024 nt
    v_lshlrev_b32 v26, 16, v72
    v_and_b32 v27, s9, v72
    v_lshlrev_b32 v28, 16, v73
    v_and_b32 v29, s9, v73
    v_lshlrev_b32 v30, 16, v74
    v_and_b32 v31, s9, v74
    v_lshlrev_b32 v32, 16, v75
    v_and_b32 v33, s9, v75
    v_fmac_f32_dpp v18, v8, v26 row_newbcast:2 row_mask:0xf bank_mask:0xf
    v_fmac_f32_dpp v19, v8, v27 row_newbcast:2 row_mask:0xf bank_mask:0xf
    v_fmac_f32_dpp v20, v8, v28 row_newbcast:2 row_mask:0xf bank_mask:0xf
    v_fmac_f32_dpp v21, v8, v29 row_newbcast:2 row_mask:0xf bank_mask:0xf
    v_fmac_f32_dpp v22, v8, v30 row_newbcast:2 row_mask:0xf bank_mask:0xf
    v_fmac_f32_dpp v23, v8, v31 row_newbcast:2 row_mask:0xf bank_mask:0xf
    v_fmac_f32_dpp v24, v8, v32 row_newbcast:2 row_mask:0xf bank_mask:0xf
    v_fmac_f32_dpp v25, v8, v33 row_newbcast:2 row_mask:0xf bank_mask:0xf
    s_waitcnt vmcnt(2)
    v_lshlrev_b32 v26, 16, v76
    v_and_b32 v27, s9, v76
    v_lshlrev_b32 v28, 16, v77
    v_and_b32 v29, s9, v77
    v_lshlrev_b32 v30, 16, v78
    v_and_b32 v31, s9, v78
    v_lshlrev_b32 v32, 16, v79
    v_and_b32 v33, s9, v79
    v_fmac_f32_dpp v18, v8, v26 row_newbcast:3 row_mask:0xf bank_mask:0xf
    v_fmac_f32_dpp v19, v8, v27 row_newbcast:3 row_mask:0xf bank_mask:0xf
    v_fmac_f32_dpp v20, v8, v28 row_newbcast:3 row_mask:0xf bank_mask:0xf
    v_fmac_f32_dpp v21, v8, v29 row_newbcast:3 row_mask:0xf bank_mask:0xf
    v_fmac_f32_dpp v22, v8, v30 row_newbcast:3 row_mask:0xf bank_mask:0xf
    v_fmac_f32_dpp v23, v8, v31 row_newbcast:3 row_mask:0xf bank_mask:0xf
    v_fmac_f32_dpp v24, v8, v32 row_newbcast:3 row_mask:0xf bank_mask:0xf
    v_fmac_f32_dpp v25, v8, v33 row_newbcast:3 row_mask:0xf bank_mask:0xf
    s_waitcnt vmcnt(1)
    buffer_load_dwordx4 v[88:91], v2, s[40:43], s45 offen offset:2048 nt
    buffer_load_dwordx4 v[92:95], v2, s[40:43], s45 offen offset:3072 nt
    v_lshlrev_b32 v26, 16, v80
    v_and_b32 v27, s9, v80
    v_lshlrev_b32 v28, 16, v81
    v_and_b32 v29, s9, v81
    v_lshlrev_b32 v30, 16, v82
    v_and_b32 v31, s9, v82
    v_lshlrev_b32 v32, 16, v83
    v_and_b32 v33, s9, v83
    v_fmac_f32_dpp v18, v8, v26 row_newbcast:4 row_mask:0xf bank_mask:0xf
    v_fmac_f32_dpp v19, v8, v27 row_newbcast:4 row_mask:0xf bank_mask:0xf
    v_fmac_f32_dpp v20, v8, v28 row_newbcast:4 row_mask:0xf bank_mask:0xf
    v_fmac_f32_dpp v21, v8, v29 row_newbcast:4 row_mask:0xf bank_mask:0xf
    v_fmac_f32_dpp v22, v8, v30 row_newbcast:4 row_mask:0xf bank_mask:0xf
    v_fmac_f32_dpp v23, v8, v31 row_newbcast:4 row_mask:0xf bank_mask:0xf
    v_fmac_f32_dpp v24, v8, v32 row_newbcast:4 row_mask:0xf bank_mask:0xf
    v_fmac_f32_dpp v25, v8, v33 row_newbcast:4 row_mask:0xf bank_mask:0xf
    s_waitcnt vmcnt(2)
    buffer_load_dwordx4 v[96:99], v2, s[40:43], s46 offen offset:0 nt
    v_lshlrev_b32 v26, 16, v84
    v_and_b32 v27, s9, v84
    v_lshlrev_b32 v28, 16, v85
    v_and_b32 v29, s9, v85
    v_lshlrev_b32 v30, 16, v86
    v_and_b32 v31, s9, v86
    v_lshlrev_b32 v32, 16, v87
    v_and_b32 v33, s9, v87
    v_fmac_f32_dpp v18, v8, v26 row_newbcast:5 row_mask:0xf bank_mask:0xf
    v_fmac_f32_dpp v19, v8, v27 row_newbcast:5 row_mask:0xf bank_mask:0xf
    v_fmac_f32_dpp v20, v8, v28 row_newbcast:5 row_mask:0xf bank_mask:0xf
    v_fmac_f32_dpp v21, v8, v29 row_newbcast:5 row_mask:0xf bank_mask:0xf
    v_fmac_f32_dpp v22, v8, v30 row_newbcast:5 row_mask:0xf bank_mask:0xf
    v_fmac_f32_dpp v23, v8, v31 row_newbcast:5 row_mask:0xf bank_mask:0xf
    v_fmac_f32_dpp v24, v8, v32 row_newbcast:5 row_mask:0xf bank_mask:0xf
    v_fmac_f32_dpp v25, v8, v33 row_newbcast:5 row_mask:0xf bank_mask:0xf
    s_waitcnt vmcnt(2)
    buffer_load_dwordx4 v[100:103], v2, s[40:43], s46 offen offset:1024 nt
    v_lshlrev_b32 v26, 16, v88
    v_and_b32 v27, s9, v88
    v_lshlrev_b32 v28, 16, v89
    v_and_b32 v29, s9, v89
    v_lshlrev_b32 v30, 16, v90
    v_and_b32 v31, s9, v90
    v_lshlrev_b32 v32, 16, v91
    v_and_b32 v33, s9, v91
    v_fmac_f32_dpp v18, v8, v26 row_newbcast:6 row_mask:0xf bank_mask:0xf
    v_fmac_f32_dpp v19, v8, v27 row_newbcast:6 row_mask:0xf bank_mask:0xf
    v_fmac_f32_dpp v20, v8, v28 row_newbcast:6 row_mask:0xf bank_mask:0xf
    v_fmac_f32_dpp v21, v8, v29 row_newbcast:6 row_mask:0xf bank_mask:0xf
    v_fmac_f32_dpp v22, v8, v30 row_newbcast:6 row_mask:0xf bank_mask:0xf
    v_fmac_f32_dpp v23, v8, v31 row_newbcast:6 row_mask:0xf bank_mask:0xf
    v_fmac_f32_dpp v24, v8, v32 row_newbcast:6 row_mask:0xf bank_mask:0xf
    v_fmac_f32_dpp v25, v8, v33 row_newbcast:6 row_mask:0xf bank_mask:0xf
    s_waitcnt vmcnt(2)
    v_lshlrev_b32 v26, 16, v92
    v_and_b32 v27, s9, v92
    v_lshlrev_b32 v28, 16, v93
    v_and_b32 v29, s9, v93
    v_lshlrev_b32 v30, 16, v94
    v_and_b32 v31, s9, v94
    v_lshlrev_b32 v32, 16, v95
    v_and_b32 v33, s9, v95
    v_fmac_f32_dpp v18, v8, v26 row_newbcast:7 row_mask:0xf bank_mask:0xf
    v_fmac_f32_dpp v19, v8, v27 row_newbcast:7 row_mask:0xf bank_mask:0xf
    v_fmac_f32_dpp v20, v8, v28 row_newbcast:7 row_mask:0xf bank_mask:0xf
    v_fmac_f32_dpp v21, v8, v29 row_newbcast:7 row_mask:0xf bank_mask:0xf
    v_fmac_f32_dpp v22, v8, v30 row_newbcast:7 row_mask:0xf bank_mask:0xf
    v_fmac_f32_dpp v23, v8, v31 row_newbcast:7 row_mask:0xf bank_mask:0xf
    v_fmac_f32_dpp v24, v8, v32 row_newbcast:7 row_mask:0xf bank_mask:0xf
    v_fmac_f32_dpp v25, v8, v33 row_newbcast:7 row_mask:0xf bank_mask:0xf
    s_waitcnt vmcnt(1)
    buffer_load_dwordx4 v[104:107], v2, s[40:43], s46 offen offset:2048 nt
    buffer_load_dwordx4 v[108:111], v2, s[40:43], s46 offen offset:3072 nt
    v_lshlrev_b32 v26, 16, v96
    v_and_b32 v27, s9, v96
    v_lshlrev_b32 v28, 16, v97
    v_and_b32 v29, s9, v97
    v_lshlrev_b32 v30, 16, v98
    v_and_b32 v31, s9, v98
    v_lshlrev_b32 v32, 16, v99
    v_and_b32 v33, s9, v99
    v_fmac_f32_dpp v18, v8, v26 row_newbcast:8 row_mask:0xf bank_mask:0xf
    v_fmac_f32_dpp v19, v8, v27 row_newbcast:8 row_mask:0xf bank_mask:0xf
    v_fmac_f32_dpp v20, v8, v28 row_newbcast:8 row_mask:0xf bank_mask:0xf
    v_fmac_f32_dpp v21, v8, v29 row_newbcast:8 row_mask:0xf bank_mask:0xf
    v_fmac_f32_dpp v22, v8, v30 row_newbcast:8 row_mask:0xf bank_mask:0xf
    v_fmac_f32_dpp v23, v8, v31 row_newbcast:8 row_mask:0xf bank_mask:0xf
    v_fmac_f32_dpp v24, v8, v32 row_newbcast:8 row_mask:0xf bank_mask:0xf
    v_fmac_f32_dpp v25, v8, v33 row_newbcast:8 row_mask:0xf bank_mask:0xf
    s_waitcnt vmcnt(2)
    buffer_load_dwordx4 v[112:115], v2, s[40:43], s47 offen offset:0 nt
    v_lshlrev_b32 v26, 16, v100
    v_and_b32 v27, s9, v100
    v_lshlrev_b32 v28, 16, v101
    v_and_b32 v29, s9, v101
    v_lshlrev_b32 v30, 16, v102
    v_and_b32 v31, s9, v102
    v_lshlrev_b32 v32, 16, v103
    v_and_b32 v33, s9, v103
    v_fmac_f32_dpp v18, v8, v26 row_newbcast:9 row_mask:0xf bank_mask:0xf
    v_fmac_f32_dpp v19, v8, v27 row_newbcast:9 row_mask:0xf bank_mask:0xf
    v_fmac_f32_dpp v20, v8, v28 row_newbcast:9 row_mask:0xf bank_mask:0xf
    v_fmac_f32_dpp v21, v8, v29 row_newbcast:9 row_mask:0xf bank_mask:0xf
    v_fmac_f32_dpp v22, v8, v30 row_newbcast:9 row_mask:0xf bank_mask:0xf
    v_fmac_f32_dpp v23, v8, v31 row_newbcast:9 row_mask:0xf bank_mask:0xf
    v_fmac_f32_dpp v24, v8, v32 row_newbcast:9 row_mask:0xf bank_mask:0xf
    v_fmac_f32_dpp v25, v8, v33 row_newbcast:9 row_mask:0xf bank_mask:0xf
    s_waitcnt vmcnt(2)
    buffer_load_dwordx4 v[116:119], v2, s[40:43], s47 offen offset:1024 nt
    v_lshlrev_b32 v26, 16, v104
    v_and_b32 v27, s9, v104
    v_lshlrev_b32 v28, 16, v105
    v_and_b32 v29, s9, v105
    v_lshlrev_b32 v30, 16, v106
    v_and_b32 v31, s9, v106
    v_lshlrev_b32 v32, 16, v107
    v_and_b32 v33, s9, v107
    v_fmac_f32_dpp v18, v8, v26 row_newbcast:10 row_mask:0xf bank_mask:0xf
    v_fmac_f32_dpp v19, v8, v27 row_newbcast:10 row_mask:0xf bank_mask:0xf
    v_fmac_f32_dpp v20, v8, v28 row_newbcast:10 row_mask:0xf bank_mask:0xf
    v_fmac_f32_dpp v21, v8, v29 row_newbcast:10 row_mask:0xf bank_mask:0xf
    v_fmac_f32_dpp v22, v8, v30 row_newbcast:10 row_mask:0xf bank_mask:0xf
    v_fmac_f32_dpp v23, v8, v31 row_newbcast:10 row_mask:0xf bank_mask:0xf
    v_fmac_f32_dpp v24, v8, v32 row_newbcast:10 row_mask:0xf bank_mask:0xf
    v_fmac_f32_dpp v25, v8, v33 row_newbcast:10 row_mask:0xf bank_mask:0xf
    s_waitcnt vmcnt(2)
    v_lshlrev_b32 v26, 16, v108
    v_and_b32 v27, s9, v108
    v_lshlrev_b32 v28, 16, v109
    v_and_b32 v29, s9, v109
    v_lshlrev_b32 v30, 16, v110
    v_and_b32 v31, s9, v110
    v_lshlrev_b32 v32, 16, v111
    v_and_b32 v33, s9, v111
    v_fmac_f32_dpp v18, v8, v26 row_newbcast:11 row_mask:0xf bank_mask:0xf
    v_fmac_f32_dpp v19, v8, v27 row_newbcast:11 row_mask:0xf bank_mask:0xf
    v_fmac_f32_dpp v20, v8, v28 row_newbcast:11 row_mask:0xf bank_mask:0xf
    v_fmac_f32_dpp v21, v8, v29 row_newbcast:11 row_mask:0xf bank_mask:0xf
    v_fmac_f32_dpp v22, v8, v30 row_newbcast:11 row_mask:0xf bank_mask:0xf
    v_fmac_f32_dpp v23, v8, v31 row_newbcast:11 row_mask:0xf bank_mask:0xf
    v_fmac_f32_dpp v24, v8, v32 row_newbcast:11 row_mask:0xf bank_mask:0xf
    v_fmac_f32_dpp v25, v8, v33 row_newbcast:11 row_mask:0xf bank_mask:0xf
    s_waitcnt vmcnt(1)
    buffer_load_dwordx4 v[120:123], v2, s[40:43], s47 offen offset:2048 nt
    buffer_load_dwordx4 v[124:127], v2, s[40:43], s47 offen offset:3072 nt
    s_add_u32 s44, s44, s8
    s_add_u32 s45, s44, 262144
    s_add_u32 s46, s44, 524288
    s_add_u32 s47, s44, 786432
    s_cmp_lg_u32 s6, 7
    s_cselect_b32 s42, s42, 0
    v_lshlrev_b32 v26, 16, v112
    v_and_b32 v27, s9, v112
    v_lshlrev_b32 v28, 16, v113
    v_and_b32 v29, s9, v113
    v_lshlrev_b32 v30, 16, v114
    v_and_b32 v31, s9, v114
    v_lshlrev_b32 v32, 16, v115
    v_and_b32 v33, s9, v115
    v_fmac_f32_dpp v18, v8, v26 row_newbcast:12 row_mask:0xf bank_mask:0xf
    v_fmac_f32_dpp v19, v8, v27 row_newbcast:12 row_mask:0xf bank_mask:0xf
    v_fmac_f32_dpp v20, v8, v28 row_newbcast:12 row_mask:0xf bank_mask:0xf
    v_fmac_f32_dpp v21, v8, v29 row_newbcast:12 row_mask:0xf bank_mask:0xf
    v_fmac_f32_dpp v22, v8, v30 row_newbcast:12 row_mask:0xf bank_mask:0xf
    v_fmac_f32_dpp v23, v8, v31 row_newbcast:12 row_mask:0xf bank_mask:0xf
    v_fmac_f32_dpp v24, v8, v32 row_newbcast:12 row_mask:0xf bank_mask:0xf
    v_fmac_f32_dpp v25, v8, v33 row_newbcast:12 row_mask:0xf bank_mask:0xf
    s_waitcnt vmcnt(2)
    buffer_load_dwordx4 v[64:67], v2, s[40:43], s44 offen offset:0 nt
    v_lshlrev_b32 v26, 16, v116
    v_and_b32 v27, s9, v116
    v_lshlrev_b32 v28, 16, v117
    v_and_b32 v29, s9, v117
    v_lshlrev_b32 v30, 16, v118
    v_and_b32 v31, s9, v118
    v_lshlrev_b32 v32, 16, v119
    v_and_b32 v33, s9, v119
    v_fmac_f32_dpp v18, v8, v26 row_newbcast:13 row_mask:0xf bank_mask:0xf
    v_fmac_f32_dpp v19, v8, v27 row_newbcast:13 row_mask:0xf bank_mask:0xf
    v_fmac_f32_dpp v20, v8, v28 row_newbcast:13 row_mask:0xf bank_mask:0xf
    v_fmac_f32_dpp v21, v8, v29 row_newbcast:13 row_mask:0xf bank_mask:0xf
    v_fmac_f32_dpp v22, v8, v30 row_newbcast:13 row_mask:0xf bank_mask:0xf
    v_fmac_f32_dpp v23, v8, v31 row_newbcast:13 row_mask:0xf bank_mask:0xf
    v_fmac_f32_dpp v24, v8, v32 row_newbcast:13 row_mask:0xf bank_mask:0xf
    v_fmac_f32_dpp v25, v8, v33 row_newbcast:13 row_mask:0xf bank_mask:0xf
    s_waitcnt vmcnt(2)
    buffer_load_dwordx4 v[68:71], v2, s[40:43], s44 offen offset:1024 nt
    v_lshlrev_b32 v26, 16, v120
    v_and_b32 v27, s9, v120
    v_lshlrev_b32 v28, 16, v121
    v_and_b32 v29, s9, v121
    v_lshlrev_b32 v30, 16, v122
    v_and_b32 v31, s9, v122
    v_lshlrev_b32 v32, 16, v123
    v_and_b32 v33, s9, v123
    v_fmac_f32_dpp v18, v8, v26 row_newbcast:14 row_mask:0xf bank_mask:0xf
    v_fmac_f32_dpp v19, v8, v27 row_newbcast:14 row_mask:0xf bank_mask:0xf
    v_fmac_f32_dpp v20, v8, v28 row_newbcast:14 row_mask:0xf bank_mask:0xf
    v_fmac_f32_dpp v21, v8, v29 row_newbcast:14 row_mask:0xf bank_mask:0xf
    v_fmac_f32_dpp v22, v8, v30 row_newbcast:14 row_mask:0xf bank_mask:0xf
    v_fmac_f32_dpp v23, v8, v31 row_newbcast:14 row_mask:0xf bank_mask:0xf
    v_fmac_f32_dpp v24, v8, v32 row_newbcast:14 row_mask:0xf bank_mask:0xf
    v_fmac_f32_dpp v25, v8, v33 row_newbcast:14 row_mask:0xf bank_mask:0xf
    s_waitcnt vmcnt(2)
    v_lshlrev_b32 v26, 16, v124
    v_and_b32 v27, s9, v124
    v_lshlrev_b32 v28, 16, v125
    v_and_b32 v29, s9, v125
    v_lshlrev_b32 v30, 16, v126
    v_and_b32 v31, s9, v126
    v_lshlrev_b32 v32, 16, v127
    v_and_b32 v33, s9, v127
    v_fmac_f32_dpp v18, v8, v26 row_newbcast:15 row_mask:0xf bank_mask:0xf
    v_fmac_f32_dpp v19, v8, v27 row_newbcast:15 row_mask:0xf bank_mask:0xf
    v_fmac_f32_dpp v20, v8, v28 row_newbcast:15 row_mask:0xf bank_mask:0xf
    v_fmac_f32_dpp v21, v8, v29 row_newbcast:15 row_mask:0xf bank_mask:0xf
    v_fmac_f32_dpp v22, v8, v30 row_newbcast:15 row_mask:0xf bank_mask:0xf
    v_fmac_f32_dpp v23, v8, v31 row_newbcast:15 row_mask:0xf bank_mask:0xf
    v_fmac_f32_dpp v24, v8, v32 row_newbcast:15 row_mask:0xf bank_mask:0xf
    v_fmac_f32_dpp v25, v8, v33 row_newbcast:15 row_mask:0xf bank_mask:0xf
    s_cmp_lg_u32 s6, 3
    s_cbranch_scc1 L_VNOP1E
    v_mov_b32 v4, 1
    s_mov_b64 exec, 1
    ds_add_u32 v5, v4 offset:1040
    s_mov_b64 exec, -1
L_VNOP1E:
    s_cmp_lg_u32 s6, 6
    s_cbranch_scc1 L_VNOP2E
    v_mov_b32 v4, 1
    s_mov_b64 exec, 1
    ds_add_u32 v5, v4 offset:1048
    s_mov_b64 exec, -1
L_VNOP2E:
    s_add_u32 s6, s6, 1
    s_cmp_lt_u32 s6, 8
    s_cbranch_scc1 L_VLOOPE
L_EPI:
    v_mov_b32 v3, 1024
    s_mov_b32 s6, 0
L_MLW:
    ds_read_b128 v[52:55], v3
    s_add_u32 s6, s6, 1
    s_cmp_gt_u32 s6, 0x400000
    s_cbranch_scc1 L_MLOK
    s_waitcnt lgkmcnt(0)
    v_readfirstlane_b32 s60, v54
    s_cmp_eq_u32 s60, 0x1234
    s_cbranch_scc1 L_MLOK
    s_sleep 2
    s_branch L_MLW
L_MLOK:
    s_waitcnt lgkmcnt(0)
    v_sub_f32 v58, v7, v52
    v_exp_f32 v58, v58
    s_nop 0
    v_mul_f32 v58, v58, v53
    v_mul_f32 v18, v18, v58
    v_mul_f32 v19, v19, v58
    v_mul_f32 v20, v20, v58
    v_mul_f32 v21, v21, v58
    v_mul_f32 v22, v22, v58
    v_mul_f32 v23, v23, v58
    v_mul_f32 v24, v24, v58
    v_mul_f32 v25, v25, v58
    s_nop 1
    v_permlane32_swap_b32 v18, v22
    v_permlane32_swap_b32 v19, v23
    v_permlane32_swap_b32 v20, v24
    v_permlane32_swap_b32 v21, v25
    s_nop 0
    v_add_f32 v18, v18, v22
    v_add_f32 v19, v19, v23
    v_add_f32 v20, v20, v24
    v_add_f32 v21, v21, v25
    s_nop 1
    v_permlane16_swap_b32 v18, v20
    v_permlane16_swap_b32 v19, v21
    s_nop 0
    v_add_f32 v18, v18, v20
    v_add_f32 v19, v19, v21
    v_and_b32 v3, 15, v1
    v_lshlrev_b32 v3, 5, v3
    v_lshrrev_b32 v4, 5, v1
    v_lshl_add_u32 v3, v4, 4, v3
    v_bfe_u32 v4, v1, 4, 1
    v_lshl_add_u32 v3, v4, 3, v3
    ds_add_f32 v3, v18 offset:512
    ds_add_f32 v3, v19 offset:516
    s_waitcnt lgkmcnt(0)
    s_barrier
    v_and_b32 v3, 15, v1
    v_lshlrev_b32 v3, 2, v3
    s_lshl_b32 s60, s5, 6
    v_add_u32 v3, s60, v3
    ds_read_b32 v8, v3 offset:512
    s_lshl_b32 s60, s5, 14
    v_add_u32 v4, s60, v2
    ds_read_b128 v[64:67], v4 offset:24576
    ds_read_b128 v[68:71], v4 offset:25600
    ds_read_b128 v[72:75], v4 offset:26624
    ds_read_b128 v[76:79], v4 offset:27648
    ds_read_b128 v[80:83], v4 offset:28672
    ds_read_b128 v[84:87], v4 offset:29696
    ds_read_b128 v[88:91], v4 offset:30720
    ds_read_b128 v[92:95], v4 offset:31744
    ds_read_b128 v[96:99], v4 offset:32768
    ds_read_b128 v[100:103], v4 offset:33792
    ds_read_b128 v[104:107], v4 offset:34816
    ds_read_b128 v[108:111], v4 offset:35840
    ds_read_b128 v[112:115], v4 offset:36864
    ds_read_b128 v[116:119], v4 offset:37888
    ds_read_b128 v[120:123], v4 offset:38912
    ds_read_b128 v[124:127], v4 offset:39936
    v_mov_b32 v18, 0
    v_mov_b32 v19, 0
    v_mov_b32 v20, 0
    v_mov_b32 v21, 0
    v_mov_b32 v22, 0
    v_mov_b32 v23, 0
    v_mov_b32 v24, 0
    v_mov_b32 v25, 0
    s_waitcnt lgkmcnt(15)
    v_lshlrev_b32 v26, 16, v64
    v_and_b32 v27, s9, v64
    v_lshlrev_b32 v28, 16, v65
    v_and_b32 v29, s9, v65
    v_lshlrev_b32 v30, 16, v66
    v_and_b32 v31, s9, v66
    v_lshlrev_b32 v32, 16, v67
    v_and_b32 v33, s9, v67
    v_fmac_f32_dpp v18, v8, v26 row_newbcast:0 row_mask:0xf bank_mask:0xf
    v_fmac_f32_dpp v19, v8, v27 row_newbcast:0 row_mask:0xf bank_mask:0xf
    v_fmac_f32_dpp v20, v8, v28 row_newbcast:0 row_mask:0xf bank_mask:0xf
    v_fmac_f32_dpp v21, v8, v29 row_newbcast:0 row_mask:0xf bank_mask:0xf
    v_fmac_f32_dpp v22, v8, v30 row_newbcast:0 row_mask:0xf bank_mask:0xf
    v_fmac_f32_dpp v23, v8, v31 row_newbcast:0 row_mask:0xf bank_mask:0xf
    v_fmac_f32_dpp v24, v8, v32 row_newbcast:0 row_mask:0xf bank_mask:0xf
    v_fmac_f32_dpp v25, v8, v33 row_newbcast:0 row_mask:0xf bank_mask:0xf
    s_waitcnt lgkmcnt(14)
    v_lshlrev_b32 v26, 16, v68
    v_and_b32 v27, s9, v68
    v_lshlrev_b32 v28, 16, v69
    v_and_b32 v29, s9, v69
    v_lshlrev_b32 v30, 16, v70
    v_and_b32 v31, s9, v70
    v_lshlrev_b32 v32, 16, v71
    v_and_b32 v33, s9, v71
    v_fmac_f32_dpp v18, v8, v26 row_newbcast:1 row_mask:0xf bank_mask:0xf
    v_fmac_f32_dpp v19, v8, v27 row_newbcast:1 row_mask:0xf bank_mask:0xf
    v_fmac_f32_dpp v20, v8, v28 row_newbcast:1 row_mask:0xf bank_mask:0xf
    v_fmac_f32_dpp v21, v8, v29 row_newbcast:1 row_mask:0xf bank_mask:0xf
    v_fmac_f32_dpp v22, v8, v30 row_newbcast:1 row_mask:0xf bank_mask:0xf
    v_fmac_f32_dpp v23, v8, v31 row_newbcast:1 row_mask:0xf bank_mask:0xf
    v_fmac_f32_dpp v24, v8, v32 row_newbcast:1 row_mask:0xf bank_mask:0xf
    v_fmac_f32_dpp v25, v8, v33 row_newbcast:1 row_mask:0xf bank_mask:0xf
    s_waitcnt lgkmcnt(13)
    v_lshlrev_b32 v26, 16, v72
    v_and_b32 v27, s9, v72
    v_lshlrev_b32 v28, 16, v73
    v_and_b32 v29, s9, v73
    v_lshlrev_b32 v30, 16, v74
    v_and_b32 v31, s9, v74
    v_lshlrev_b32 v32, 16, v75
    v_and_b32 v33, s9, v75
    v_fmac_f32_dpp v18, v8, v26 row_newbcast:2 row_mask:0xf bank_mask:0xf
    v_fmac_f32_dpp v19, v8, v27 row_newbcast:2 row_mask:0xf bank_mask:0xf
    v_fmac_f32_dpp v20, v8, v28 row_newbcast:2 row_mask:0xf bank_mask:0xf
    v_fmac_f32_dpp v21, v8, v29 row_newbcast:2 row_mask:0xf bank_mask:0xf
    v_fmac_f32_dpp v22, v8, v30 row_newbcast:2 row_mask:0xf bank_mask:0xf
    v_fmac_f32_dpp v23, v8, v31 row_newbcast:2 row_mask:0xf bank_mask:0xf
    v_fmac_f32_dpp v24, v8, v32 row_newbcast:2 row_mask:0xf bank_mask:0xf
    v_fmac_f32_dpp v25, v8, v33 row_newbcast:2 row_mask:0xf bank_mask:0xf
    s_waitcnt lgkmcnt(12)
    v_lshlrev_b32 v26, 16, v76
    v_and_b32 v27, s9, v76
    v_lshlrev_b32 v28, 16, v77
    v_and_b32 v29, s9, v77
    v_lshlrev_b32 v30, 16, v78
    v_and_b32 v31, s9, v78
    v_lshlrev_b32 v32, 16, v79
    v_and_b32 v33, s9, v79
    v_fmac_f32_dpp v18, v8, v26 row_newbcast:3 row_mask:0xf bank_mask:0xf
    v_fmac_f32_dpp v19, v8, v27 row_newbcast:3 row_mask:0xf bank_mask:0xf
    v_fmac_f32_dpp v20, v8, v28 row_newbcast:3 row_mask:0xf bank_mask:0xf
    v_fmac_f32_dpp v21, v8, v29 row_newbcast:3 row_mask:0xf bank_mask:0xf
    v_fmac_f32_dpp v22, v8, v30 row_newbcast:3 row_mask:0xf bank_mask:0xf
    v_fmac_f32_dpp v23, v8, v31 row_newbcast:3 row_mask:0xf bank_mask:0xf
    v_fmac_f32_dpp v24, v8, v32 row_newbcast:3 row_mask:0xf bank_mask:0xf
    v_fmac_f32_dpp v25, v8, v33 row_newbcast:3 row_mask:0xf bank_mask:0xf
    s_waitcnt lgkmcnt(11)
    v_lshlrev_b32 v26, 16, v80
    v_and_b32 v27, s9, v80
    v_lshlrev_b32 v28, 16, v81
    v_and_b32 v29, s9, v81
    v_lshlrev_b32 v30, 16, v82
    v_and_b32 v31, s9, v82
    v_lshlrev_b32 v32, 16, v83
    v_and_b32 v33, s9, v83
    v_fmac_f32_dpp v18, v8, v26 row_newbcast:4 row_mask:0xf bank_mask:0xf
    v_fmac_f32_dpp v19, v8, v27 row_newbcast:4 row_mask:0xf bank_mask:0xf
    v_fmac_f32_dpp v20, v8, v28 row_newbcast:4 row_mask:0xf bank_mask:0xf
    v_fmac_f32_dpp v21, v8, v29 row_newbcast:4 row_mask:0xf bank_mask:0xf
    v_fmac_f32_dpp v22, v8, v30 row_newbcast:4 row_mask:0xf bank_mask:0xf
    v_fmac_f32_dpp v23, v8, v31 row_newbcast:4 row_mask:0xf bank_mask:0xf
    v_fmac_f32_dpp v24, v8, v32 row_newbcast:4 row_mask:0xf bank_mask:0xf
    v_fmac_f32_dpp v25, v8, v33 row_newbcast:4 row_mask:0xf bank_mask:0xf
    s_waitcnt lgkmcnt(10)
    v_lshlrev_b32 v26, 16, v84
    v_and_b32 v27, s9, v84
    v_lshlrev_b32 v28, 16, v85
    v_and_b32 v29, s9, v85
    v_lshlrev_b32 v30, 16, v86
    v_and_b32 v31, s9, v86
    v_lshlrev_b32 v32, 16, v87
    v_and_b32 v33, s9, v87
    v_fmac_f32_dpp v18, v8, v26 row_newbcast:5 row_mask:0xf bank_mask:0xf
    v_fmac_f32_dpp v19, v8, v27 row_newbcast:5 row_mask:0xf bank_mask:0xf
    v_fmac_f32_dpp v20, v8, v28 row_newbcast:5 row_mask:0xf bank_mask:0xf
    v_fmac_f32_dpp v21, v8, v29 row_newbcast:5 row_mask:0xf bank_mask:0xf
    v_fmac_f32_dpp v22, v8, v30 row_newbcast:5 row_mask:0xf bank_mask:0xf
    v_fmac_f32_dpp v23, v8, v31 row_newbcast:5 row_mask:0xf bank_mask:0xf
    v_fmac_f32_dpp v24, v8, v32 row_newbcast:5 row_mask:0xf bank_mask:0xf
    v_fmac_f32_dpp v25, v8, v33 row_newbcast:5 row_mask:0xf bank_mask:0xf
    s_waitcnt lgkmcnt(9)
    v_lshlrev_b32 v26, 16, v88
    v_and_b32 v27, s9, v88
    v_lshlrev_b32 v28, 16, v89
    v_and_b32 v29, s9, v89
    v_lshlrev_b32 v30, 16, v90
    v_and_b32 v31, s9, v90
    v_lshlrev_b32 v32, 16, v91
    v_and_b32 v33, s9, v91
    v_fmac_f32_dpp v18, v8, v26 row_newbcast:6 row_mask:0xf bank_mask:0xf
    v_fmac_f32_dpp v19, v8, v27 row_newbcast:6 row_mask:0xf bank_mask:0xf
    v_fmac_f32_dpp v20, v8, v28 row_newbcast:6 row_mask:0xf bank_mask:0xf
    v_fmac_f32_dpp v21, v8, v29 row_newbcast:6 row_mask:0xf bank_mask:0xf
    v_fmac_f32_dpp v22, v8, v30 row_newbcast:6 row_mask:0xf bank_mask:0xf
    v_fmac_f32_dpp v23, v8, v31 row_newbcast:6 row_mask:0xf bank_mask:0xf
    v_fmac_f32_dpp v24, v8, v32 row_newbcast:6 row_mask:0xf bank_mask:0xf
    v_fmac_f32_dpp v25, v8, v33 row_newbcast:6 row_mask:0xf bank_mask:0xf
    s_waitcnt lgkmcnt(8)
    v_lshlrev_b32 v26, 16, v92
    v_and_b32 v27, s9, v92
    v_lshlrev_b32 v28, 16, v93
    v_and_b32 v29, s9, v93
    v_lshlrev_b32 v30, 16, v94
    v_and_b32 v31, s9, v94
    v_lshlrev_b32 v32, 16, v95
    v_and_b32 v33, s9, v95
    v_fmac_f32_dpp v18, v8, v26 row_newbcast:7 row_mask:0xf bank_mask:0xf
    v_fmac_f32_dpp v19, v8, v27 row_newbcast:7 row_mask:0xf bank_mask:0xf
    v_fmac_f32_dpp v20, v8, v28 row_newbcast:7 row_mask:0xf bank_mask:0xf
    v_fmac_f32_dpp v21, v8, v29 row_newbcast:7 row_mask:0xf bank_mask:0xf
    v_fmac_f32_dpp v22, v8, v30 row_newbcast:7 row_mask:0xf bank_mask:0xf
    v_fmac_f32_dpp v23, v8, v31 row_newbcast:7 row_mask:0xf bank_mask:0xf
    v_fmac_f32_dpp v24, v8, v32 row_newbcast:7 row_mask:0xf bank_mask:0xf
    v_fmac_f32_dpp v25, v8, v33 row_newbcast:7 row_mask:0xf bank_mask:0xf
    s_waitcnt lgkmcnt(7)
    v_lshlrev_b32 v26, 16, v96
    v_and_b32 v27, s9, v96
    v_lshlrev_b32 v28, 16, v97
    v_and_b32 v29, s9, v97
    v_lshlrev_b32 v30, 16, v98
    v_and_b32 v31, s9, v98
    v_lshlrev_b32 v32, 16, v99
    v_and_b32 v33, s9, v99
    v_fmac_f32_dpp v18, v8, v26 row_newbcast:8 row_mask:0xf bank_mask:0xf
    v_fmac_f32_dpp v19, v8, v27 row_newbcast:8 row_mask:0xf bank_mask:0xf
    v_fmac_f32_dpp v20, v8, v28 row_newbcast:8 row_mask:0xf bank_mask:0xf
    v_fmac_f32_dpp v21, v8, v29 row_newbcast:8 row_mask:0xf bank_mask:0xf
    v_fmac_f32_dpp v22, v8, v30 row_newbcast:8 row_mask:0xf bank_mask:0xf
    v_fmac_f32_dpp v23, v8, v31 row_newbcast:8 row_mask:0xf bank_mask:0xf
    v_fmac_f32_dpp v24, v8, v32 row_newbcast:8 row_mask:0xf bank_mask:0xf
    v_fmac_f32_dpp v25, v8, v33 row_newbcast:8 row_mask:0xf bank_mask:0xf
    s_waitcnt lgkmcnt(6)
    v_lshlrev_b32 v26, 16, v100
    v_and_b32 v27, s9, v100
    v_lshlrev_b32 v28, 16, v101
    v_and_b32 v29, s9, v101
    v_lshlrev_b32 v30, 16, v102
    v_and_b32 v31, s9, v102
    v_lshlrev_b32 v32, 16, v103
    v_and_b32 v33, s9, v103
    v_fmac_f32_dpp v18, v8, v26 row_newbcast:9 row_mask:0xf bank_mask:0xf
    v_fmac_f32_dpp v19, v8, v27 row_newbcast:9 row_mask:0xf bank_mask:0xf
    v_fmac_f32_dpp v20, v8, v28 row_newbcast:9 row_mask:0xf bank_mask:0xf
    v_fmac_f32_dpp v21, v8, v29 row_newbcast:9 row_mask:0xf bank_mask:0xf
    v_fmac_f32_dpp v22, v8, v30 row_newbcast:9 row_mask:0xf bank_mask:0xf
    v_fmac_f32_dpp v23, v8, v31 row_newbcast:9 row_mask:0xf bank_mask:0xf
    v_fmac_f32_dpp v24, v8, v32 row_newbcast:9 row_mask:0xf bank_mask:0xf
    v_fmac_f32_dpp v25, v8, v33 row_newbcast:9 row_mask:0xf bank_mask:0xf
    s_waitcnt lgkmcnt(5)
    v_lshlrev_b32 v26, 16, v104
    v_and_b32 v27, s9, v104
    v_lshlrev_b32 v28, 16, v105
    v_and_b32 v29, s9, v105
    v_lshlrev_b32 v30, 16, v106
    v_and_b32 v31, s9, v106
    v_lshlrev_b32 v32, 16, v107
    v_and_b32 v33, s9, v107
    v_fmac_f32_dpp v18, v8, v26 row_newbcast:10 row_mask:0xf bank_mask:0xf
    v_fmac_f32_dpp v19, v8, v27 row_newbcast:10 row_mask:0xf bank_mask:0xf
    v_fmac_f32_dpp v20, v8, v28 row_newbcast:10 row_mask:0xf bank_mask:0xf
    v_fmac_f32_dpp v21, v8, v29 row_newbcast:10 row_mask:0xf bank_mask:0xf
    v_fmac_f32_dpp v22, v8, v30 row_newbcast:10 row_mask:0xf bank_mask:0xf
    v_fmac_f32_dpp v23, v8, v31 row_newbcast:10 row_mask:0xf bank_mask:0xf
    v_fmac_f32_dpp v24, v8, v32 row_newbcast:10 row_mask:0xf bank_mask:0xf
    v_fmac_f32_dpp v25, v8, v33 row_newbcast:10 row_mask:0xf bank_mask:0xf
    s_waitcnt lgkmcnt(4)
    v_lshlrev_b32 v26, 16, v108
    v_and_b32 v27, s9, v108
    v_lshlrev_b32 v28, 16, v109
    v_and_b32 v29, s9, v109
    v_lshlrev_b32 v30, 16, v110
    v_and_b32 v31, s9, v110
    v_lshlrev_b32 v32, 16, v111
    v_and_b32 v33, s9, v111
    v_fmac_f32_dpp v18, v8, v26 row_newbcast:11 row_mask:0xf bank_mask:0xf
    v_fmac_f32_dpp v19, v8, v27 row_newbcast:11 row_mask:0xf bank_mask:0xf
    v_fmac_f32_dpp v20, v8, v28 row_newbcast:11 row_mask:0xf bank_mask:0xf
    v_fmac_f32_dpp v21, v8, v29 row_newbcast:11 row_mask:0xf bank_mask:0xf
    v_fmac_f32_dpp v22, v8, v30 row_newbcast:11 row_mask:0xf bank_mask:0xf
    v_fmac_f32_dpp v23, v8, v31 row_newbcast:11 row_mask:0xf bank_mask:0xf
    v_fmac_f32_dpp v24, v8, v32 row_newbcast:11 row_mask:0xf bank_mask:0xf
    v_fmac_f32_dpp v25, v8, v33 row_newbcast:11 row_mask:0xf bank_mask:0xf
    s_waitcnt lgkmcnt(3)
    v_lshlrev_b32 v26, 16, v112
    v_and_b32 v27, s9, v112
    v_lshlrev_b32 v28, 16, v113
    v_and_b32 v29, s9, v113
    v_lshlrev_b32 v30, 16, v114
    v_and_b32 v31, s9, v114
    v_lshlrev_b32 v32, 16, v115
    v_and_b32 v33, s9, v115
    v_fmac_f32_dpp v18, v8, v26 row_newbcast:12 row_mask:0xf bank_mask:0xf
    v_fmac_f32_dpp v19, v8, v27 row_newbcast:12 row_mask:0xf bank_mask:0xf
    v_fmac_f32_dpp v20, v8, v28 row_newbcast:12 row_mask:0xf bank_mask:0xf
    v_fmac_f32_dpp v21, v8, v29 row_newbcast:12 row_mask:0xf bank_mask:0xf
    v_fmac_f32_dpp v22, v8, v30 row_newbcast:12 row_mask:0xf bank_mask:0xf
    v_fmac_f32_dpp v23, v8, v31 row_newbcast:12 row_mask:0xf bank_mask:0xf
    v_fmac_f32_dpp v24, v8, v32 row_newbcast:12 row_mask:0xf bank_mask:0xf
    v_fmac_f32_dpp v25, v8, v33 row_newbcast:12 row_mask:0xf bank_mask:0xf
    s_waitcnt lgkmcnt(2)
    v_lshlrev_b32 v26, 16, v116
    v_and_b32 v27, s9, v116
    v_lshlrev_b32 v28, 16, v117
    v_and_b32 v29, s9, v117
    v_lshlrev_b32 v30, 16, v118
    v_and_b32 v31, s9, v118
    v_lshlrev_b32 v32, 16, v119
    v_and_b32 v33, s9, v119
    v_fmac_f32_dpp v18, v8, v26 row_newbcast:13 row_mask:0xf bank_mask:0xf
    v_fmac_f32_dpp v19, v8, v27 row_newbcast:13 row_mask:0xf bank_mask:0xf
    v_fmac_f32_dpp v20, v8, v28 row_newbcast:13 row_mask:0xf bank_mask:0xf
    v_fmac_f32_dpp v21, v8, v29 row_newbcast:13 row_mask:0xf bank_mask:0xf
    v_fmac_f32_dpp v22, v8, v30 row_newbcast:13 row_mask:0xf bank_mask:0xf
    v_fmac_f32_dpp v23, v8, v31 row_newbcast:13 row_mask:0xf bank_mask:0xf
    v_fmac_f32_dpp v24, v8, v32 row_newbcast:13 row_mask:0xf bank_mask:0xf
    v_fmac_f32_dpp v25, v8, v33 row_newbcast:13 row_mask:0xf bank_mask:0xf
    s_waitcnt lgkmcnt(1)
    v_lshlrev_b32 v26, 16, v120
    v_and_b32 v27, s9, v120
    v_lshlrev_b32 v28, 16, v121
    v_and_b32 v29, s9, v121
    v_lshlrev_b32 v30, 16, v122
    v_and_b32 v31, s9, v122
    v_lshlrev_b32 v32, 16, v123
    v_and_b32 v33, s9, v123
    v_fmac_f32_dpp v18, v8, v26 row_newbcast:14 row_mask:0xf bank_mask:0xf
    v_fmac_f32_dpp v19, v8, v27 row_newbcast:14 row_mask:0xf bank_mask:0xf
    v_fmac_f32_dpp v20, v8, v28 row_newbcast:14 row_mask:0xf bank_mask:0xf
    v_fmac_f32_dpp v21, v8, v29 row_newbcast:14 row_mask:0xf bank_mask:0xf
    v_fmac_f32_dpp v22, v8, v30 row_newbcast:14 row_mask:0xf bank_mask:0xf
    v_fmac_f32_dpp v23, v8, v31 row_newbcast:14 row_mask:0xf bank_mask:0xf
    v_fmac_f32_dpp v24, v8, v32 row_newbcast:14 row_mask:0xf bank_mask:0xf
    v_fmac_f32_dpp v25, v8, v33 row_newbcast:14 row_mask:0xf bank_mask:0xf
    s_waitcnt lgkmcnt(0)
    v_lshlrev_b32 v26, 16, v124
    v_and_b32 v27, s9, v124
    v_lshlrev_b32 v28, 16, v125
    v_and_b32 v29, s9, v125
    v_lshlrev_b32 v30, 16, v126
    v_and_b32 v31, s9, v126
    v_lshlrev_b32 v32, 16, v127
    v_and_b32 v33, s9, v127
    v_fmac_f32_dpp v18, v8, v26 row_newbcast:15 row_mask:0xf bank_mask:0xf
    v_fmac_f32_dpp v19, v8, v27 row_newbcast:15 row_mask:0xf bank_mask:0xf
    v_fmac_f32_dpp v20, v8, v28 row_newbcast:15 row_mask:0xf bank_mask:0xf
    v_fmac_f32_dpp v21, v8, v29 row_newbcast:15 row_mask:0xf bank_mask:0xf
    v_fmac_f32_dpp v22, v8, v30 row_newbcast:15 row_mask:0xf bank_mask:0xf
    v_fmac_f32_dpp v23, v8, v31 row_newbcast:15 row_mask:0xf bank_mask:0xf
    v_fmac_f32_dpp v24, v8, v32 row_newbcast:15 row_mask:0xf bank_mask:0xf
    v_fmac_f32_dpp v25, v8, v33 row_newbcast:15 row_mask:0xf bank_mask:0xf
    v_lshlrev_b32 v3, 5, v1
    s_lshl_b32 s60, s5, 11
    v_add_u32 v3, s60, v3
    v_mov_b32 v56, v18
    v_mov_b32 v57, v19
    v_mov_b32 v58, v20
    v_mov_b32 v59, v21
    v_mov_b32 v60, v22
    v_mov_b32 v61, v23
    v_mov_b32 v62, v24
    v_mov_b32 v63, v25
    ds_write_b128 v3, v[56:59] offset:8192
    ds_write_b128 v3, v[60:63] offset:8208
    s_waitcnt lgkmcnt(0)
    s_barrier
    v_lshlrev_b32 v3, 2, v0
    ds_read_b32 v34, v3 offset:8192
    ds_read_b32 v35, v3 offset:10240
    ds_read_b32 v36, v3 offset:12288
    ds_read_b32 v37, v3 offset:14336
    ds_read_b32 v38, v3 offset:16384
    ds_read_b32 v39, v3 offset:18432
    ds_read_b32 v40, v3 offset:20480
    ds_read_b32 v41, v3 offset:22528
    ds_read_b32 v42, v3 offset:2048
    s_waitcnt lgkmcnt(0)
    v_add_f32 v34, v34, v35
    v_add_f32 v34, v34, v36
    v_add_f32 v34, v34, v37
    v_add_f32 v34, v34, v38
    v_add_f32 v34, v34, v39
    v_add_f32 v34, v34, v40
    v_add_f32 v34, v34, v41
    v_add_f32 v34, v34, v42
    s_and_b32 s60, s2, 7
    s_lshl_b32 s60, s60, 11
    s_add_u32 s60, s60, 393216
    s_add_u32 s68, s38, s60
    s_addc_u32 s69, s39, 0
    global_atomic_add_f32 v3, v34, s[68:69]
    s_waitcnt vmcnt(0)
    s_barrier
    s_cmp_lg_u32 s5, 0
    s_cbranch_scc1 L_END
    v_mov_b32 v4, 1
    s_mov_b64 exec, 1
    global_atomic_add v56, v5, v4, s[36:37] offset:128 sc0
    s_waitcnt vmcnt(0)
    s_mov_b64 exec, -1
    v_readfirstlane_b32 s60, v56
    s_cmp_lg_u32 s60, 255
    s_cbranch_scc1 L_END
    s_add_u32 s68, s38, 393216
    s_addc_u32 s69, s39, 0
    v_lshlrev_b32 v3, 5, v1
    global_load_dwordx4 v[64:67], v3, s[68:69] offset:0 sc1
    global_load_dwordx4 v[68:71], v3, s[68:69] offset:16 sc1
    global_load_dwordx4 v[72:75], v3, s[68:69] offset:2048 sc1
    global_load_dwordx4 v[76:79], v3, s[68:69] offset:2064 sc1
    v_add_u32 v3, 4096, v3
    global_load_dwordx4 v[80:83], v3, s[68:69] offset:0 sc1
    global_load_dwordx4 v[84:87], v3, s[68:69] offset:16 sc1
    global_load_dwordx4 v[88:91], v3, s[68:69] offset:2048 sc1
    global_load_dwordx4 v[92:95], v3, s[68:69] offset:2064 sc1
    v_add_u32 v3, 4096, v3
    global_load_dwordx4 v[96:99], v3, s[68:69] offset:0 sc1
    global_load_dwordx4 v[100:103], v3, s[68:69] offset:16 sc1
    global_load_dwordx4 v[104:107], v3, s[68:69] offset:2048 sc1
    global_load_dwordx4 v[108:111], v3, s[68:69] offset:2064 sc1
    v_add_u32 v3, 4096, v3
    global_load_dwordx4 v[112:115], v3, s[68:69] offset:0 sc1
    global_load_dwordx4 v[116:119], v3, s[68:69] offset:16 sc1
    global_load_dwordx4 v[120:123], v3, s[68:69] offset:2048 sc1
    global_load_dwordx4 v[124:127], v3, s[68:69] offset:2064 sc1
    s_waitcnt vmcnt(0)
    v_add_f32 v64, v64, v72
    v_add_f32 v65, v65, v73
    v_add_f32 v66, v66, v74
    v_add_f32 v67, v67, v75
    v_add_f32 v68, v68, v76
    v_add_f32 v69, v69, v77
    v_add_f32 v70, v70, v78
    v_add_f32 v71, v71, v79
    v_add_f32 v64, v64, v80
    v_add_f32 v65, v65, v81
    v_add_f32 v66, v66, v82
    v_add_f32 v67, v67, v83
    v_add_f32 v68, v68, v84
    v_add_f32 v69, v69, v85
    v_add_f32 v70, v70, v86
    v_add_f32 v71, v71, v87
    v_add_f32 v64, v64, v88
    v_add_f32 v65, v65, v89
    v_add_f32 v66, v66, v90
    v_add_f32 v67, v67, v91
    v_add_f32 v68, v68, v92
    v_add_f32 v69, v69, v93
    v_add_f32 v70, v70, v94
    v_add_f32 v71, v71, v95
    v_add_f32 v64, v64, v96
    v_add_f32 v65, v65, v97
    v_add_f32 v66, v66, v98
    v_add_f32 v67, v67, v99
    v_add_f32 v68, v68, v100
    v_add_f32 v69, v69, v101
    v_add_f32 v70, v70, v102
    v_add_f32 v71, v71, v103
    v_add_f32 v64, v64, v104
    v_add_f32 v65, v65, v105
    v_add_f32 v66, v66, v106
    v_add_f32 v67, v67, v107
    v_add_f32 v68, v68, v108
    v_add_f32 v69, v69, v109
    v_add_f32 v70, v70, v110
    v_add_f32 v71, v71, v111
    v_add_f32 v64, v64, v112
    v_add_f32 v65, v65, v113
    v_add_f32 v66, v66, v114
    v_add_f32 v67, v67, v115
    v_add_f32 v68, v68, v116
    v_add_f32 v69, v69, v117
    v_add_f32 v70, v70, v118
    v_add_f32 v71, v71, v119
    v_add_f32 v64, v64, v120
    v_add_f32 v65, v65, v121
    v_add_f32 v66, v66, v122
    v_add_f32 v67, v67, v123
    v_add_f32 v68, v68, v124
    v_add_f32 v69, v69, v125
    v_add_f32 v70, v70, v126
    v_add_f32 v71, v71, v127
    v_cvt_pk_bf16_f32 v52, v64, v65
    v_cvt_pk_bf16_f32 v53, v66, v67
    v_cvt_pk_bf16_f32 v54, v68, v69
    v_cvt_pk_bf16_f32 v55, v70, v71
    global_store_dwordx4 v2, v[52:55], s[34:35]
    s_endpgm
L_SVC:
    s_sub_u32 s7, s5, 8
    v_lshlrev_b32 v3, 3, v1
    v_mov_b32 v56, 0
    v_mov_b32 v57, 0
    ds_write_b64 v3, v[56:57] offset:0
    ds_write_b64 v3, v[56:57] offset:512
    ds_write_b64 v5, v[56:57] offset:1032
    ds_write_b64 v5, v[56:57] offset:1040
    ds_write_b64 v5, v[56:57] offset:1048
    ds_write_b64 v5, v[56:57] offset:1056
    v_lshrrev_b32 v3, 4, v1
    v_and_b32 v4, 15, v1
    v_lshlrev_b32 v3, 13, v3
    v_lshl_add_u32 v58, v4, 4, v3
    s_lshl_b32 s70, s7, 20
    s_lshl_b32 s61, s3, 8
    s_add_u32 s70, s70, s61
    s_mov_b32 s58, 4194304
    s_mov_b32 s59, 0x00020000
    s_waitcnt lgkmcnt(0)
    global_load_dwordx4 v[52:55], v2, s[16:17]
    s_mov_b32 s56, s22
    s_mov_b32 s57, s23
    buffer_load_dwordx4 v[64:67], v58, s[56:59], s70 offen
    s_add_u32 s70, s70, 32768
    buffer_load_dwordx4 v[68:71], v58, s[56:59], s70 offen
    s_add_u32 s70, s70, 32768
    buffer_load_dwordx4 v[72:75], v58, s[56:59], s70 offen
    s_add_u32 s70, s70, 32768
    buffer_load_dwordx4 v[76:79], v58, s[56:59], s70 offen
    s_add_u32 s70, s70, 32768
    buffer_load_dwordx4 v[80:83], v58, s[56:59], s70 offen
    s_add_u32 s70, s70, 32768
    buffer_load_dwordx4 v[84:87], v58, s[56:59], s70 offen
    s_add_u32 s70, s70, 32768
    buffer_load_dwordx4 v[88:91], v58, s[56:59], s70 offen
    s_add_u32 s70, s70, 32768
    buffer_load_dwordx4 v[92:95], v58, s[56:59], s70 offen
    s_add_u32 s70, s70, 32768
    s_barrier
    buffer_load_dwordx4 v[96:99], v58, s[56:59], s70 offen
    s_add_u32 s70, s70, 32768
    buffer_load_dwordx4 v[100:103], v58, s[56:59], s70 offen
    s_add_u32 s70, s70, 32768
    buffer_load_dwordx4 v[104:107], v58, s[56:59], s70 offen
    s_add_u32 s70, s70, 32768
    buffer_load_dwordx4 v[108:111], v58, s[56:59], s70 offen
    s_add_u32 s70, s70, 32768
    buffer_load_dwordx4 v[112:115], v58, s[56:59], s70 offen
    s_add_u32 s70, s70, 32768
    buffer_load_dwordx4 v[116:119], v58, s[56:59], s70 offen
    s_add_u32 s70, s70, 32768
    buffer_load_dwordx4 v[120:123], v58, s[56:59], s70 offen
    s_add_u32 s70, s70, 32768
    buffer_load_dwordx4 v[124:127], v58, s[56:59], s70 offen
    s_add_u32 s70, s70, 32768
    buffer_load_dwordx4 v[128:131], v58, s[56:59], s70 offen
    s_add_u32 s70, s70, 32768
    buffer_load_dwordx4 v[132:135], v58, s[56:59], s70 offen
    s_add_u32 s70, s70, 32768
    buffer_load_dwordx4 v[136:139], v58, s[56:59], s70 offen
    s_add_u32 s70, s70, 32768
    buffer_load_dwordx4 v[140:143], v58, s[56:59], s70 offen
    s_add_u32 s70, s70, 32768
    buffer_load_dwordx4 v[144:147], v58, s[56:59], s70 offen
    s_add_u32 s70, s70, 32768
    buffer_load_dwordx4 v[148:151], v58, s[56:59], s70 offen
    s_add_u32 s70, s70, 32768
    buffer_load_dwordx4 v[152:155], v58, s[56:59], s70 offen
    s_add_u32 s70, s70, 32768
    buffer_load_dwordx4 v[156:159], v58, s[56:59], s70 offen
    s_add_u32 s70, s70, 32768
    s_lshl_b32 s60, s3, 2
    s_add_u32 s66, s36, s60
    s_addc_u32 s67, s37, 0
    s_waitcnt vmcnt(24)
    v_lshlrev_b32 v26, 16, v52
    v_and_b32 v27, s9, v52
    v_lshlrev_b32 v28, 16, v53
    v_and_b32 v29, s9, v53
    v_lshlrev_b32 v30, 16, v54
    v_and_b32 v31, s9, v54
    v_lshlrev_b32 v32, 16, v55
    v_and_b32 v33, s9, v55
    v_lshlrev_b32 v3, 5, v1
    v_mov_b32 v34, v26
    v_mov_b32 v35, v27
    v_mov_b32 v36, v28
    v_mov_b32 v37, v29
    v_mov_b32 v38, v30
    v_mov_b32 v39, v31
    v_mov_b32 v40, v32
    v_mov_b32 v41, v33
    v_add_f32 v56, v26, v27
    v_add_f32 v56, v56, v28
    v_add_f32 v56, v56, v29
    v_add_f32 v56, v56, v30
    v_add_f32 v56, v56, v31
    v_add_f32 v56, v56, v32
    v_add_f32 v56, v56, v33
    s_nop 1
    v_add_f32_dpp v56, v56, v56 row_ror:8 row_mask:0xf bank_mask:0xf
    s_nop 1
    v_add_f32_dpp v56, v56, v56 row_ror:4 row_mask:0xf bank_mask:0xf
    s_nop 1
    v_add_f32_dpp v56, v56, v56 row_ror:2 row_mask:0xf bank_mask:0xf
    s_nop 1
    v_add_f32_dpp v56, v56, v56 row_ror:1 row_mask:0xf bank_mask:0xf
    s_nop 0
    v_readlane_b32 s60, v56, 0
    v_readlane_b32 s61, v56, 16
    v_readlane_b32 s62, v56, 32
    v_readlane_b32 s63, v56, 48
    s_nop 1
    v_mov_b32 v56, s60
    v_add_f32 v56, s61, v56
    v_add_f32 v56, s62, v56
    v_add_f32 v56, s63, v56
    v_mul_f32 v56, 0x3b000000, v56
    v_sub_f32 v26, v26, v56
    v_sub_f32 v27, v27, v56
    v_sub_f32 v28, v28, v56
    v_sub_f32 v29, v29, v56
    v_sub_f32 v30, v30, v56
    v_sub_f32 v31, v31, v56
    v_sub_f32 v32, v32, v56
    v_sub_f32 v33, v33, v56
    v_mul_f32 v57, v26, v26
    v_fmac_f32 v57, v27, v27
    v_fmac_f32 v57, v28, v28
    v_fmac_f32 v57, v29, v29
    v_fmac_f32 v57, v30, v30
    v_fmac_f32 v57, v31, v31
    v_fmac_f32 v57, v32, v32
    v_fmac_f32 v57, v33, v33
    s_nop 1
    v_add_f32_dpp v57, v57, v57 row_ror:8 row_mask:0xf bank_mask:0xf
    s_nop 1
    v_add_f32_dpp v57, v57, v57 row_ror:4 row_mask:0xf bank_mask:0xf
    s_nop 1
    v_add_f32_dpp v57, v57, v57 row_ror:2 row_mask:0xf bank_mask:0xf
    s_nop 1
    v_add_f32_dpp v57, v57, v57 row_ror:1 row_mask:0xf bank_mask:0xf
    s_nop 0
    v_readlane_b32 s60, v57, 0
    v_readlane_b32 s61, v57, 16
    v_readlane_b32 s62, v57, 32
    v_readlane_b32 s63, v57, 48
    s_nop 1
    v_mov_b32 v57, s60
    v_add_f32 v57, s61, v57
    v_add_f32 v57, s62, v57
    v_add_f32 v57, s63, v57
    v_mov_b32 v56, 0x3727c5ac
    v_fmac_f32 v56, 0x3b000000, v57
    v_rsq_f32 v56, v56
    s_nop 0
    v_mul_f32 v10, v26, v56
    v_mul_f32 v11, v27, v56
    v_mul_f32 v12, v28, v56
    v_mul_f32 v13, v29, v56
    v_mul_f32 v14, v30, v56
    v_mul_f32 v15, v31, v56
    v_mul_f32 v16, v32, v56
    v_mul_f32 v17, v33, v56
    s_nop 1
    ds_write_b128 v3, v[10:13] offset:4096
    ds_write_b128 v3, v[14:17] offset:4112
    ds_write_b128 v3, v[34:37] offset:6144
    ds_write_b128 v3, v[38:41] offset:6160
    v_and_b32 v3, 15, v1
    v_lshrrev_b32 v4, 4, v1
    v_lshl_add_u32 v3, v3, 2, v4
    v_lshlrev_b32 v3, 2, v3
    s_lshl_b32 s60, s7, 9
    v_add_u32 v3, s60, v3
    s_waitcnt lgkmcnt(0)
    ds_read_b32 v8, v3 offset:4096
    ds_read_b32 v9, v3 offset:4352
    v_mov_b32 v18, 0
    v_mov_b32 v19, 0
    v_mov_b32 v20, 0
    v_mov_b32 v21, 0
    v_mov_b32 v22, 0
    v_mov_b32 v23, 0
    v_mov_b32 v24, 0
    v_mov_b32 v25, 0
    s_waitcnt lgkmcnt(0)
    s_waitcnt vmcnt(23)
    v_lshlrev_b32 v26, 16, v64
    v_and_b32 v27, s9, v64
    v_lshlrev_b32 v28, 16, v65
    v_and_b32 v29, s9, v65
    v_lshlrev_b32 v30, 16, v66
    v_and_b32 v31, s9, v66
    v_lshlrev_b32 v32, 16, v67
    v_and_b32 v33, s9, v67
    buffer_load_dwordx4 v[64:67], v58, s[56:59], s70 offen
    s_add_u32 s70, s70, 32768
    v_fmac_f32_dpp v18, v8, v26 row_newbcast:0 row_mask:0xf bank_mask:0xf
    v_fmac_f32_dpp v19, v8, v27 row_newbcast:0 row_mask:0xf bank_mask:0xf
    v_fmac_f32_dpp v20, v8, v28 row_newbcast:0 row_mask:0xf bank_mask:0xf
    v_fmac_f32_dpp v21, v8, v29 row_newbcast:0 row_mask:0xf bank_mask:0xf
    v_fmac_f32_dpp v22, v8, v30 row_newbcast:0 row_mask:0xf bank_mask:0xf
    v_fmac_f32_dpp v23, v8, v31 row_newbcast:0 row_mask:0xf bank_mask:0xf
    v_fmac_f32_dpp v24, v8, v32 row_newbcast:0 row_mask:0xf bank_mask:0xf
    v_fmac_f32_dpp v25, v8, v33 row_newbcast:0 row_mask:0xf bank_mask:0xf
    s_waitcnt vmcnt(23)
    v_lshlrev_b32 v26, 16, v68
    v_and_b32 v27, s9, v68
    v_lshlrev_b32 v28, 16, v69
    v_and_b32 v29, s9, v69
    v_lshlrev_b32 v30, 16, v70
    v_and_b32 v31, s9, v70
    v_lshlrev_b32 v32, 16, v71
    v_and_b32 v33, s9, v71
    buffer_load_dwordx4 v[68:71], v58, s[56:59], s70 offen
    s_add_u32 s70, s70, 32768
    v_fmac_f32_dpp v18, v8, v26 row_newbcast:1 row_mask:0xf bank_mask:0xf
    v_fmac_f32_dpp v19, v8, v27 row_newbcast:1 row_mask:0xf bank_mask:0xf
    v_fmac_f32_dpp v20, v8, v28 row_newbcast:1 row_mask:0xf bank_mask:0xf
    v_fmac_f32_dpp v21, v8, v29 row_newbcast:1 row_mask:0xf bank_mask:0xf
    v_fmac_f32_dpp v22, v8, v30 row_newbcast:1 row_mask:0xf bank_mask:0xf
    v_fmac_f32_dpp v23, v8, v31 row_newbcast:1 row_mask:0xf bank_mask:0xf
    v_fmac_f32_dpp v24, v8, v32 row_newbcast:1 row_mask:0xf bank_mask:0xf
    v_fmac_f32_dpp v25, v8, v33 row_newbcast:1 row_mask:0xf bank_mask:0xf
    s_waitcnt vmcnt(23)
    v_lshlrev_b32 v26, 16, v72
    v_and_b32 v27, s9, v72
    v_lshlrev_b32 v28, 16, v73
    v_and_b32 v29, s9, v73
    v_lshlrev_b32 v30, 16, v74
    v_and_b32 v31, s9, v74
    v_lshlrev_b32 v32, 16, v75
    v_and_b32 v33, s9, v75
    buffer_load_dwordx4 v[72:75], v58, s[56:59], s70 offen
    s_add_u32 s70, s70, 32768
    v_fmac_f32_dpp v18, v8, v26 row_newbcast:2 row_mask:0xf bank_mask:0xf
    v_fmac_f32_dpp v19, v8, v27 row_newbcast:2 row_mask:0xf bank_mask:0xf
    v_fmac_f32_dpp v20, v8, v28 row_newbcast:2 row_mask:0xf bank_mask:0xf
    v_fmac_f32_dpp v21, v8, v29 row_newbcast:2 row_mask:0xf bank_mask:0xf
    v_fmac_f32_dpp v22, v8, v30 row_newbcast:2 row_mask:0xf bank_mask:0xf
    v_fmac_f32_dpp v23, v8, v31 row_newbcast:2 row_mask:0xf bank_mask:0xf
    v_fmac_f32_dpp v24, v8, v32 row_newbcast:2 row_mask:0xf bank_mask:0xf
    v_fmac_f32_dpp v25, v8, v33 row_newbcast:2 row_mask:0xf bank_mask:0xf
    s_waitcnt vmcnt(23)
    v_lshlrev_b32 v26, 16, v76
    v_and_b32 v27, s9, v76
    v_lshlrev_b32 v28, 16, v77
    v_and_b32 v29, s9, v77
    v_lshlrev_b32 v30, 16, v78
    v_and_b32 v31, s9, v78
    v_lshlrev_b32 v32, 16, v79
    v_and_b32 v33, s9, v79
    buffer_load_dwordx4 v[76:79], v58, s[56:59], s70 offen
    s_add_u32 s70, s70, 32768
    v_fmac_f32_dpp v18, v8, v26 row_newbcast:3 row_mask:0xf bank_mask:0xf
    v_fmac_f32_dpp v19, v8, v27 row_newbcast:3 row_mask:0xf bank_mask:0xf
    v_fmac_f32_dpp v20, v8, v28 row_newbcast:3 row_mask:0xf bank_mask:0xf
    v_fmac_f32_dpp v21, v8, v29 row_newbcast:3 row_mask:0xf bank_mask:0xf
    v_fmac_f32_dpp v22, v8, v30 row_newbcast:3 row_mask:0xf bank_mask:0xf
    v_fmac_f32_dpp v23, v8, v31 row_newbcast:3 row_mask:0xf bank_mask:0xf
    v_fmac_f32_dpp v24, v8, v32 row_newbcast:3 row_mask:0xf bank_mask:0xf
    v_fmac_f32_dpp v25, v8, v33 row_newbcast:3 row_mask:0xf bank_mask:0xf
    s_waitcnt vmcnt(23)
    v_lshlrev_b32 v26, 16, v80
    v_and_b32 v27, s9, v80
    v_lshlrev_b32 v28, 16, v81
    v_and_b32 v29, s9, v81
    v_lshlrev_b32 v30, 16, v82
    v_and_b32 v31, s9, v82
    v_lshlrev_b32 v32, 16, v83
    v_and_b32 v33, s9, v83
    buffer_load_dwordx4 v[80:83], v58, s[56:59], s70 offen
    s_add_u32 s70, s70, 32768
    v_fmac_f32_dpp v18, v8, v26 row_newbcast:4 row_mask:0xf bank_mask:0xf
    v_fmac_f32_dpp v19, v8, v27 row_newbcast:4 row_mask:0xf bank_mask:0xf
    v_fmac_f32_dpp v20, v8, v28 row_newbcast:4 row_mask:0xf bank_mask:0xf
    v_fmac_f32_dpp v21, v8, v29 row_newbcast:4 row_mask:0xf bank_mask:0xf
    v_fmac_f32_dpp v22, v8, v30 row_newbcast:4 row_mask:0xf bank_mask:0xf
    v_fmac_f32_dpp v23, v8, v31 row_newbcast:4 row_mask:0xf bank_mask:0xf
    v_fmac_f32_dpp v24, v8, v32 row_newbcast:4 row_mask:0xf bank_mask:0xf
    v_fmac_f32_dpp v25, v8, v33 row_newbcast:4 row_mask:0xf bank_mask:0xf
    s_waitcnt vmcnt(23)
    v_lshlrev_b32 v26, 16, v84
    v_and_b32 v27, s9, v84
    v_lshlrev_b32 v28, 16, v85
    v_and_b32 v29, s9, v85
    v_lshlrev_b32 v30, 16, v86
    v_and_b32 v31, s9, v86
    v_lshlrev_b32 v32, 16, v87
    v_and_b32 v33, s9, v87
    buffer_load_dwordx4 v[84:87], v58, s[56:59], s70 offen
    s_add_u32 s70, s70, 32768
    v_fmac_f32_dpp v18, v8, v26 row_newbcast:5 row_mask:0xf bank_mask:0xf
    v_fmac_f32_dpp v19, v8, v27 row_newbcast:5 row_mask:0xf bank_mask:0xf
    v_fmac_f32_dpp v20, v8, v28 row_newbcast:5 row_mask:0xf bank_mask:0xf
    v_fmac_f32_dpp v21, v8, v29 row_newbcast:5 row_mask:0xf bank_mask:0xf
    v_fmac_f32_dpp v22, v8, v30 row_newbcast:5 row_mask:0xf bank_mask:0xf
    v_fmac_f32_dpp v23, v8, v31 row_newbcast:5 row_mask:0xf bank_mask:0xf
    v_fmac_f32_dpp v24, v8, v32 row_newbcast:5 row_mask:0xf bank_mask:0xf
    v_fmac_f32_dpp v25, v8, v33 row_newbcast:5 row_mask:0xf bank_mask:0xf
    s_waitcnt vmcnt(23)
    v_lshlrev_b32 v26, 16, v88
    v_and_b32 v27, s9, v88
    v_lshlrev_b32 v28, 16, v89
    v_and_b32 v29, s9, v89
    v_lshlrev_b32 v30, 16, v90
    v_and_b32 v31, s9, v90
    v_lshlrev_b32 v32, 16, v91
    v_and_b32 v33, s9, v91
    buffer_load_dwordx4 v[88:91], v58, s[56:59], s70 offen
    s_add_u32 s70, s70, 32768
    v_fmac_f32_dpp v18, v8, v26 row_newbcast:6 row_mask:0xf bank_mask:0xf
    v_fmac_f32_dpp v19, v8, v27 row_newbcast:6 row_mask:0xf bank_mask:0xf
    v_fmac_f32_dpp v20, v8, v28 row_newbcast:6 row_mask:0xf bank_mask:0xf
    v_fmac_f32_dpp v21, v8, v29 row_newbcast:6 row_mask:0xf bank_mask:0xf
    v_fmac_f32_dpp v22, v8, v30 row_newbcast:6 row_mask:0xf bank_mask:0xf
    v_fmac_f32_dpp v23, v8, v31 row_newbcast:6 row_mask:0xf bank_mask:0xf
    v_fmac_f32_dpp v24, v8, v32 row_newbcast:6 row_mask:0xf bank_mask:0xf
    v_fmac_f32_dpp v25, v8, v33 row_newbcast:6 row_mask:0xf bank_mask:0xf
    s_waitcnt vmcnt(23)
    v_lshlrev_b32 v26, 16, v92
    v_and_b32 v27, s9, v92
    v_lshlrev_b32 v28, 16, v93
    v_and_b32 v29, s9, v93
    v_lshlrev_b32 v30, 16, v94
    v_and_b32 v31, s9, v94
    v_lshlrev_b32 v32, 16, v95
    v_and_b32 v33, s9, v95
    buffer_load_dwordx4 v[92:95], v58, s[56:59], s70 offen
    v_fmac_f32_dpp v18, v8, v26 row_newbcast:7 row_mask:0xf bank_mask:0xf
    v_fmac_f32_dpp v19, v8, v27 row_newbcast:7 row_mask:0xf bank_mask:0xf
    v_fmac_f32_dpp v20, v8, v28 row_newbcast:7 row_mask:0xf bank_mask:0xf
    v_fmac_f32_dpp v21, v8, v29 row_newbcast:7 row_mask:0xf bank_mask:0xf
    v_fmac_f32_dpp v22, v8, v30 row_newbcast:7 row_mask:0xf bank_mask:0xf
    v_fmac_f32_dpp v23, v8, v31 row_newbcast:7 row_mask:0xf bank_mask:0xf
    v_fmac_f32_dpp v24, v8, v32 row_newbcast:7 row_mask:0xf bank_mask:0xf
    v_fmac_f32_dpp v25, v8, v33 row_newbcast:7 row_mask:0xf bank_mask:0xf
    s_waitcnt vmcnt(23)
    v_lshlrev_b32 v26, 16, v96
    v_and_b32 v27, s9, v96
    v_lshlrev_b32 v28, 16, v97
    v_and_b32 v29, s9, v97
    v_lshlrev_b32 v30, 16, v98
    v_and_b32 v31, s9, v98
    v_lshlrev_b32 v32, 16, v99
    v_and_b32 v33, s9, v99
    v_fmac_f32_dpp v18, v8, v26 row_newbcast:8 row_mask:0xf bank_mask:0xf
    v_fmac_f32_dpp v19, v8, v27 row_newbcast:8 row_mask:0xf bank_mask:0xf
    v_fmac_f32_dpp v20, v8, v28 row_newbcast:8 row_mask:0xf bank_mask:0xf
    v_fmac_f32_dpp v21, v8, v29 row_newbcast:8 row_mask:0xf bank_mask:0xf
    v_fmac_f32_dpp v22, v8, v30 row_newbcast:8 row_mask:0xf bank_mask:0xf
    v_fmac_f32_dpp v23, v8, v31 row_newbcast:8 row_mask:0xf bank_mask:0xf
    v_fmac_f32_dpp v24, v8, v32 row_newbcast:8 row_mask:0xf bank_mask:0xf
    v_fmac_f32_dpp v25, v8, v33 row_newbcast:8 row_mask:0xf bank_mask:0xf
    s_waitcnt vmcnt(22)
    v_lshlrev_b32 v26, 16, v100
    v_and_b32 v27, s9, v100
    v_lshlrev_b32 v28, 16, v101
    v_and_b32 v29, s9, v101
    v_lshlrev_b32 v30, 16, v102
    v_and_b32 v31, s9, v102
    v_lshlrev_b32 v32, 16, v103
    v_and_b32 v33, s9, v103
    v_fmac_f32_dpp v18, v8, v26 row_newbcast:9 row_mask:0xf bank_mask:0xf
    v_fmac_f32_dpp v19, v8, v27 row_newbcast:9 row_mask:0xf bank_mask:0xf
    v_fmac_f32_dpp v20, v8, v28 row_newbcast:9 row_mask:0xf bank_mask:0xf
    v_fmac_f32_dpp v21, v8, v29 row_newbcast:9 row_mask:0xf bank_mask:0xf
    v_fmac_f32_dpp v22, v8, v30 row_newbcast:9 row_mask:0xf bank_mask:0xf
    v_fmac_f32_dpp v23, v8, v31 row_newbcast:9 row_mask:0xf bank_mask:0xf
    v_fmac_f32_dpp v24, v8, v32 row_newbcast:9 row_mask:0xf bank_mask:0xf
    v_fmac_f32_dpp v25, v8, v33 row_newbcast:9 row_mask:0xf bank_mask:0xf
    s_waitcnt vmcnt(21)
    v_lshlrev_b32 v26, 16, v104
    v_and_b32 v27, s9, v104
    v_lshlrev_b32 v28, 16, v105
    v_and_b32 v29, s9, v105
    v_lshlrev_b32 v30, 16, v106
    v_and_b32 v31, s9, v106
    v_lshlrev_b32 v32, 16, v107
    v_and_b32 v33, s9, v107
    v_fmac_f32_dpp v18, v8, v26 row_newbcast:10 row_mask:0xf bank_mask:0xf
    v_fmac_f32_dpp v19, v8, v27 row_newbcast:10 row_mask:0xf bank_mask:0xf
    v_fmac_f32_dpp v20, v8, v28 row_newbcast:10 row_mask:0xf bank_mask:0xf
    v_fmac_f32_dpp v21, v8, v29 row_newbcast:10 row_mask:0xf bank_mask:0xf
    v_fmac_f32_dpp v22, v8, v30 row_newbcast:10 row_mask:0xf bank_mask:0xf
    v_fmac_f32_dpp v23, v8, v31 row_newbcast:10 row_mask:0xf bank_mask:0xf
    v_fmac_f32_dpp v24, v8, v32 row_newbcast:10 row_mask:0xf bank_mask:0xf
    v_fmac_f32_dpp v25, v8, v33 row_newbcast:10 row_mask:0xf bank_mask:0xf
    s_waitcnt vmcnt(20)
    v_lshlrev_b32 v26, 16, v108
    v_and_b32 v27, s9, v108
    v_lshlrev_b32 v28, 16, v109
    v_and_b32 v29, s9, v109
    v_lshlrev_b32 v30, 16, v110
    v_and_b32 v31, s9, v110
    v_lshlrev_b32 v32, 16, v111
    v_and_b32 v33, s9, v111
    v_fmac_f32_dpp v18, v8, v26 row_newbcast:11 row_mask:0xf bank_mask:0xf
    v_fmac_f32_dpp v19, v8, v27 row_newbcast:11 row_mask:0xf bank_mask:0xf
    v_fmac_f32_dpp v20, v8, v28 row_newbcast:11 row_mask:0xf bank_mask:0xf
    v_fmac_f32_dpp v21, v8, v29 row_newbcast:11 row_mask:0xf bank_mask:0xf
    v_fmac_f32_dpp v22, v8, v30 row_newbcast:11 row_mask:0xf bank_mask:0xf
    v_fmac_f32_dpp v23, v8, v31 row_newbcast:11 row_mask:0xf bank_mask:0xf
    v_fmac_f32_dpp v24, v8, v32 row_newbcast:11 row_mask:0xf bank_mask:0xf
    v_fmac_f32_dpp v25, v8, v33 row_newbcast:11 row_mask:0xf bank_mask:0xf
    s_waitcnt vmcnt(19)
    v_lshlrev_b32 v26, 16, v112
    v_and_b32 v27, s9, v112
    v_lshlrev_b32 v28, 16, v113
    v_and_b32 v29, s9, v113
    v_lshlrev_b32 v30, 16, v114
    v_and_b32 v31, s9, v114
    v_lshlrev_b32 v32, 16, v115
    v_and_b32 v33, s9, v115
    v_fmac_f32_dpp v18, v8, v26 row_newbcast:12 row_mask:0xf bank_mask:0xf
    v_fmac_f32_dpp v19, v8, v27 row_newbcast:12 row_mask:0xf bank_mask:0xf
    v_fmac_f32_dpp v20, v8, v28 row_newbcast:12 row_mask:0xf bank_mask:0xf
    v_fmac_f32_dpp v21, v8, v29 row_newbcast:12 row_mask:0xf bank_mask:0xf
    v_fmac_f32_dpp v22, v8, v30 row_newbcast:12 row_mask:0xf bank_mask:0xf
    v_fmac_f32_dpp v23, v8, v31 row_newbcast:12 row_mask:0xf bank_mask:0xf
    v_fmac_f32_dpp v24, v8, v32 row_newbcast:12 row_mask:0xf bank_mask:0xf
    v_fmac_f32_dpp v25, v8, v33 row_newbcast:12 row_mask:0xf bank_mask:0xf
    s_waitcnt vmcnt(18)
    v_lshlrev_b32 v26, 16, v116
    v_and_b32 v27, s9, v116
    v_lshlrev_b32 v28, 16, v117
    v_and_b32 v29, s9, v117
    v_lshlrev_b32 v30, 16, v118
    v_and_b32 v31, s9, v118
    v_lshlrev_b32 v32, 16, v119
    v_and_b32 v33, s9, v119
    v_fmac_f32_dpp v18, v8, v26 row_newbcast:13 row_mask:0xf bank_mask:0xf
    v_fmac_f32_dpp v19, v8, v27 row_newbcast:13 row_mask:0xf bank_mask:0xf
    v_fmac_f32_dpp v20, v8, v28 row_newbcast:13 row_mask:0xf bank_mask:0xf
    v_fmac_f32_dpp v21, v8, v29 row_newbcast:13 row_mask:0xf bank_mask:0xf
    v_fmac_f32_dpp v22, v8, v30 row_newbcast:13 row_mask:0xf bank_mask:0xf
    v_fmac_f32_dpp v23, v8, v31 row_newbcast:13 row_mask:0xf bank_mask:0xf
    v_fmac_f32_dpp v24, v8, v32 row_newbcast:13 row_mask:0xf bank_mask:0xf
    v_fmac_f32_dpp v25, v8, v33 row_newbcast:13 row_mask:0xf bank_mask:0xf
    s_waitcnt vmcnt(17)
    v_lshlrev_b32 v26, 16, v120
    v_and_b32 v27, s9, v120
    v_lshlrev_b32 v28, 16, v121
    v_and_b32 v29, s9, v121
    v_lshlrev_b32 v30, 16, v122
    v_and_b32 v31, s9, v122
    v_lshlrev_b32 v32, 16, v123
    v_and_b32 v33, s9, v123
    v_fmac_f32_dpp v18, v8, v26 row_newbcast:14 row_mask:0xf bank_mask:0xf
    v_fmac_f32_dpp v19, v8, v27 row_newbcast:14 row_mask:0xf bank_mask:0xf
    v_fmac_f32_dpp v20, v8, v28 row_newbcast:14 row_mask:0xf bank_mask:0xf
    v_fmac_f32_dpp v21, v8, v29 row_newbcast:14 row_mask:0xf bank_mask:0xf
    v_fmac_f32_dpp v22, v8, v30 row_newbcast:14 row_mask:0xf bank_mask:0xf
    v_fmac_f32_dpp v23, v8, v31 row_newbcast:14 row_mask:0xf bank_mask:0xf
    v_fmac_f32_dpp v24, v8, v32 row_newbcast:14 row_mask:0xf bank_mask:0xf
    v_fmac_f32_dpp v25, v8, v33 row_newbcast:14 row_mask:0xf bank_mask:0xf
    s_waitcnt vmcnt(16)
    v_lshlrev_b32 v26, 16, v124
    v_and_b32 v27, s9, v124
    v_lshlrev_b32 v28, 16, v125
    v_and_b32 v29, s9, v125
    v_lshlrev_b32 v30, 16, v126
    v_and_b32 v31, s9, v126
    v_lshlrev_b32 v32, 16, v127
    v_and_b32 v33, s9, v127
    v_fmac_f32_dpp v18, v8, v26 row_newbcast:15 row_mask:0xf bank_mask:0xf
    v_fmac_f32_dpp v19, v8, v27 row_newbcast:15 row_mask:0xf bank_mask:0xf
    v_fmac_f32_dpp v20, v8, v28 row_newbcast:15 row_mask:0xf bank_mask:0xf
    v_fmac_f32_dpp v21, v8, v29 row_newbcast:15 row_mask:0xf bank_mask:0xf
    v_fmac_f32_dpp v22, v8, v30 row_newbcast:15 row_mask:0xf bank_mask:0xf
    v_fmac_f32_dpp v23, v8, v31 row_newbcast:15 row_mask:0xf bank_mask:0xf
    v_fmac_f32_dpp v24, v8, v32 row_newbcast:15 row_mask:0xf bank_mask:0xf
    v_fmac_f32_dpp v25, v8, v33 row_newbcast:15 row_mask:0xf bank_mask:0xf
    s_waitcnt vmcnt(15)
    v_lshlrev_b32 v26, 16, v128
    v_and_b32 v27, s9, v128
    v_lshlrev_b32 v28, 16, v129
    v_and_b32 v29, s9, v129
    v_lshlrev_b32 v30, 16, v130
    v_and_b32 v31, s9, v130
    v_lshlrev_b32 v32, 16, v131
    v_and_b32 v33, s9, v131
    v_fmac_f32_dpp v18, v9, v26 row_newbcast:0 row_mask:0xf bank_mask:0xf
    v_fmac_f32_dpp v19, v9, v27 row_newbcast:0 row_mask:0xf bank_mask:0xf
    v_fmac_f32_dpp v20, v9, v28 row_newbcast:0 row_mask:0xf bank_mask:0xf
    v_fmac_f32_dpp v21, v9, v29 row_newbcast:0 row_mask:0xf bank_mask:0xf
    v_fmac_f32_dpp v22, v9, v30 row_newbcast:0 row_mask:0xf bank_mask:0xf
    v_fmac_f32_dpp v23, v9, v31 row_newbcast:0 row_mask:0xf bank_mask:0xf
    v_fmac_f32_dpp v24, v9, v32 row_newbcast:0 row_mask:0xf bank_mask:0xf
    v_fmac_f32_dpp v25, v9, v33 row_newbcast:0 row_mask:0xf bank_mask:0xf
    s_waitcnt vmcnt(14)
    v_lshlrev_b32 v26, 16, v132
    v_and_b32 v27, s9, v132
    v_lshlrev_b32 v28, 16, v133
    v_and_b32 v29, s9, v133
    v_lshlrev_b32 v30, 16, v134
    v_and_b32 v31, s9, v134
    v_lshlrev_b32 v32, 16, v135
    v_and_b32 v33, s9, v135
    v_fmac_f32_dpp v18, v9, v26 row_newbcast:1 row_mask:0xf bank_mask:0xf
    v_fmac_f32_dpp v19, v9, v27 row_newbcast:1 row_mask:0xf bank_mask:0xf
    v_fmac_f32_dpp v20, v9, v28 row_newbcast:1 row_mask:0xf bank_mask:0xf
    v_fmac_f32_dpp v21, v9, v29 row_newbcast:1 row_mask:0xf bank_mask:0xf
    v_fmac_f32_dpp v22, v9, v30 row_newbcast:1 row_mask:0xf bank_mask:0xf
    v_fmac_f32_dpp v23, v9, v31 row_newbcast:1 row_mask:0xf bank_mask:0xf
    v_fmac_f32_dpp v24, v9, v32 row_newbcast:1 row_mask:0xf bank_mask:0xf
    v_fmac_f32_dpp v25, v9, v33 row_newbcast:1 row_mask:0xf bank_mask:0xf
    s_waitcnt vmcnt(13)
    v_lshlrev_b32 v26, 16, v136
    v_and_b32 v27, s9, v136
    v_lshlrev_b32 v28, 16, v137
    v_and_b32 v29, s9, v137
    v_lshlrev_b32 v30, 16, v138
    v_and_b32 v31, s9, v138
    v_lshlrev_b32 v32, 16, v139
    v_and_b32 v33, s9, v139
    v_fmac_f32_dpp v18, v9, v26 row_newbcast:2 row_mask:0xf bank_mask:0xf
    v_fmac_f32_dpp v19, v9, v27 row_newbcast:2 row_mask:0xf bank_mask:0xf
    v_fmac_f32_dpp v20, v9, v28 row_newbcast:2 row_mask:0xf bank_mask:0xf
    v_fmac_f32_dpp v21, v9, v29 row_newbcast:2 row_mask:0xf bank_mask:0xf
    v_fmac_f32_dpp v22, v9, v30 row_newbcast:2 row_mask:0xf bank_mask:0xf
    v_fmac_f32_dpp v23, v9, v31 row_newbcast:2 row_mask:0xf bank_mask:0xf
    v_fmac_f32_dpp v24, v9, v32 row_newbcast:2 row_mask:0xf bank_mask:0xf
    v_fmac_f32_dpp v25, v9, v33 row_newbcast:2 row_mask:0xf bank_mask:0xf
    s_waitcnt vmcnt(12)
    v_lshlrev_b32 v26, 16, v140
    v_and_b32 v27, s9, v140
    v_lshlrev_b32 v28, 16, v141
    v_and_b32 v29, s9, v141
    v_lshlrev_b32 v30, 16, v142
    v_and_b32 v31, s9, v142
    v_lshlrev_b32 v32, 16, v143
    v_and_b32 v33, s9, v143
    v_fmac_f32_dpp v18, v9, v26 row_newbcast:3 row_mask:0xf bank_mask:0xf
    v_fmac_f32_dpp v19, v9, v27 row_newbcast:3 row_mask:0xf bank_mask:0xf
    v_fmac_f32_dpp v20, v9, v28 row_newbcast:3 row_mask:0xf bank_mask:0xf
    v_fmac_f32_dpp v21, v9, v29 row_newbcast:3 row_mask:0xf bank_mask:0xf
    v_fmac_f32_dpp v22, v9, v30 row_newbcast:3 row_mask:0xf bank_mask:0xf
    v_fmac_f32_dpp v23, v9, v31 row_newbcast:3 row_mask:0xf bank_mask:0xf
    v_fmac_f32_dpp v24, v9, v32 row_newbcast:3 row_mask:0xf bank_mask:0xf
    v_fmac_f32_dpp v25, v9, v33 row_newbcast:3 row_mask:0xf bank_mask:0xf
    s_waitcnt vmcnt(11)
    v_lshlrev_b32 v26, 16, v144
    v_and_b32 v27, s9, v144
    v_lshlrev_b32 v28, 16, v145
    v_and_b32 v29, s9, v145
    v_lshlrev_b32 v30, 16, v146
    v_and_b32 v31, s9, v146
    v_lshlrev_b32 v32, 16, v147
    v_and_b32 v33, s9, v147
    v_fmac_f32_dpp v18, v9, v26 row_newbcast:4 row_mask:0xf bank_mask:0xf
    v_fmac_f32_dpp v19, v9, v27 row_newbcast:4 row_mask:0xf bank_mask:0xf
    v_fmac_f32_dpp v20, v9, v28 row_newbcast:4 row_mask:0xf bank_mask:0xf
    v_fmac_f32_dpp v21, v9, v29 row_newbcast:4 row_mask:0xf bank_mask:0xf
    v_fmac_f32_dpp v22, v9, v30 row_newbcast:4 row_mask:0xf bank_mask:0xf
    v_fmac_f32_dpp v23, v9, v31 row_newbcast:4 row_mask:0xf bank_mask:0xf
    v_fmac_f32_dpp v24, v9, v32 row_newbcast:4 row_mask:0xf bank_mask:0xf
    v_fmac_f32_dpp v25, v9, v33 row_newbcast:4 row_mask:0xf bank_mask:0xf
    s_waitcnt vmcnt(10)
    v_lshlrev_b32 v26, 16, v148
    v_and_b32 v27, s9, v148
    v_lshlrev_b32 v28, 16, v149
    v_and_b32 v29, s9, v149
    v_lshlrev_b32 v30, 16, v150
    v_and_b32 v31, s9, v150
    v_lshlrev_b32 v32, 16, v151
    v_and_b32 v33, s9, v151
    v_fmac_f32_dpp v18, v9, v26 row_newbcast:5 row_mask:0xf bank_mask:0xf
    v_fmac_f32_dpp v19, v9, v27 row_newbcast:5 row_mask:0xf bank_mask:0xf
    v_fmac_f32_dpp v20, v9, v28 row_newbcast:5 row_mask:0xf bank_mask:0xf
    v_fmac_f32_dpp v21, v9, v29 row_newbcast:5 row_mask:0xf bank_mask:0xf
    v_fmac_f32_dpp v22, v9, v30 row_newbcast:5 row_mask:0xf bank_mask:0xf
    v_fmac_f32_dpp v23, v9, v31 row_newbcast:5 row_mask:0xf bank_mask:0xf
    v_fmac_f32_dpp v24, v9, v32 row_newbcast:5 row_mask:0xf bank_mask:0xf
    v_fmac_f32_dpp v25, v9, v33 row_newbcast:5 row_mask:0xf bank_mask:0xf
    s_waitcnt vmcnt(9)
    v_lshlrev_b32 v26, 16, v152
    v_and_b32 v27, s9, v152
    v_lshlrev_b32 v28, 16, v153
    v_and_b32 v29, s9, v153
    v_lshlrev_b32 v30, 16, v154
    v_and_b32 v31, s9, v154
    v_lshlrev_b32 v32, 16, v155
    v_and_b32 v33, s9, v155
    v_fmac_f32_dpp v18, v9, v26 row_newbcast:6 row_mask:0xf bank_mask:0xf
    v_fmac_f32_dpp v19, v9, v27 row_newbcast:6 row_mask:0xf bank_mask:0xf
    v_fmac_f32_dpp v20, v9, v28 row_newbcast:6 row_mask:0xf bank_mask:0xf
    v_fmac_f32_dpp v21, v9, v29 row_newbcast:6 row_mask:0xf bank_mask:0xf
    v_fmac_f32_dpp v22, v9, v30 row_newbcast:6 row_mask:0xf bank_mask:0xf
    v_fmac_f32_dpp v23, v9, v31 row_newbcast:6 row_mask:0xf bank_mask:0xf
    v_fmac_f32_dpp v24, v9, v32 row_newbcast:6 row_mask:0xf bank_mask:0xf
    v_fmac_f32_dpp v25, v9, v33 row_newbcast:6 row_mask:0xf bank_mask:0xf
    s_waitcnt vmcnt(8)
    v_lshlrev_b32 v26, 16, v156
    v_and_b32 v27, s9, v156
    v_lshlrev_b32 v28, 16, v157
    v_and_b32 v29, s9, v157
    v_lshlrev_b32 v30, 16, v158
    v_and_b32 v31, s9, v158
    v_lshlrev_b32 v32, 16, v159
    v_and_b32 v33, s9, v159
    v_fmac_f32_dpp v18, v9, v26 row_newbcast:7 row_mask:0xf bank_mask:0xf
    v_fmac_f32_dpp v19, v9, v27 row_newbcast:7 row_mask:0xf bank_mask:0xf
    v_fmac_f32_dpp v20, v9, v28 row_newbcast:7 row_mask:0xf bank_mask:0xf
    v_fmac_f32_dpp v21, v9, v29 row_newbcast:7 row_mask:0xf bank_mask:0xf
    v_fmac_f32_dpp v22, v9, v30 row_newbcast:7 row_mask:0xf bank_mask:0xf
    v_fmac_f32_dpp v23, v9, v31 row_newbcast:7 row_mask:0xf bank_mask:0xf
    v_fmac_f32_dpp v24, v9, v32 row_newbcast:7 row_mask:0xf bank_mask:0xf
    v_fmac_f32_dpp v25, v9, v33 row_newbcast:7 row_mask:0xf bank_mask:0xf
    s_waitcnt vmcnt(7)
    v_lshlrev_b32 v26, 16, v64
    v_and_b32 v27, s9, v64
    v_lshlrev_b32 v28, 16, v65
    v_and_b32 v29, s9, v65
    v_lshlrev_b32 v30, 16, v66
    v_and_b32 v31, s9, v66
    v_lshlrev_b32 v32, 16, v67
    v_and_b32 v33, s9, v67
    v_fmac_f32_dpp v18, v9, v26 row_newbcast:8 row_mask:0xf bank_mask:0xf
    v_fmac_f32_dpp v19, v9, v27 row_newbcast:8 row_mask:0xf bank_mask:0xf
    v_fmac_f32_dpp v20, v9, v28 row_newbcast:8 row_mask:0xf bank_mask:0xf
    v_fmac_f32_dpp v21, v9, v29 row_newbcast:8 row_mask:0xf bank_mask:0xf
    v_fmac_f32_dpp v22, v9, v30 row_newbcast:8 row_mask:0xf bank_mask:0xf
    v_fmac_f32_dpp v23, v9, v31 row_newbcast:8 row_mask:0xf bank_mask:0xf
    v_fmac_f32_dpp v24, v9, v32 row_newbcast:8 row_mask:0xf bank_mask:0xf
    v_fmac_f32_dpp v25, v9, v33 row_newbcast:8 row_mask:0xf bank_mask:0xf
    s_waitcnt vmcnt(6)
    v_lshlrev_b32 v26, 16, v68
    v_and_b32 v27, s9, v68
    v_lshlrev_b32 v28, 16, v69
    v_and_b32 v29, s9, v69
    v_lshlrev_b32 v30, 16, v70
    v_and_b32 v31, s9, v70
    v_lshlrev_b32 v32, 16, v71
    v_and_b32 v33, s9, v71
    v_fmac_f32_dpp v18, v9, v26 row_newbcast:9 row_mask:0xf bank_mask:0xf
    v_fmac_f32_dpp v19, v9, v27 row_newbcast:9 row_mask:0xf bank_mask:0xf
    v_fmac_f32_dpp v20, v9, v28 row_newbcast:9 row_mask:0xf bank_mask:0xf
    v_fmac_f32_dpp v21, v9, v29 row_newbcast:9 row_mask:0xf bank_mask:0xf
    v_fmac_f32_dpp v22, v9, v30 row_newbcast:9 row_mask:0xf bank_mask:0xf
    v_fmac_f32_dpp v23, v9, v31 row_newbcast:9 row_mask:0xf bank_mask:0xf
    v_fmac_f32_dpp v24, v9, v32 row_newbcast:9 row_mask:0xf bank_mask:0xf
    v_fmac_f32_dpp v25, v9, v33 row_newbcast:9 row_mask:0xf bank_mask:0xf
    s_waitcnt vmcnt(5)
    v_lshlrev_b32 v26, 16, v72
    v_and_b32 v27, s9, v72
    v_lshlrev_b32 v28, 16, v73
    v_and_b32 v29, s9, v73
    v_lshlrev_b32 v30, 16, v74
    v_and_b32 v31, s9, v74
    v_lshlrev_b32 v32, 16, v75
    v_and_b32 v33, s9, v75
    v_fmac_f32_dpp v18, v9, v26 row_newbcast:10 row_mask:0xf bank_mask:0xf
    v_fmac_f32_dpp v19, v9, v27 row_newbcast:10 row_mask:0xf bank_mask:0xf
    v_fmac_f32_dpp v20, v9, v28 row_newbcast:10 row_mask:0xf bank_mask:0xf
    v_fmac_f32_dpp v21, v9, v29 row_newbcast:10 row_mask:0xf bank_mask:0xf
    v_fmac_f32_dpp v22, v9, v30 row_newbcast:10 row_mask:0xf bank_mask:0xf
    v_fmac_f32_dpp v23, v9, v31 row_newbcast:10 row_mask:0xf bank_mask:0xf
    v_fmac_f32_dpp v24, v9, v32 row_newbcast:10 row_mask:0xf bank_mask:0xf
    v_fmac_f32_dpp v25, v9, v33 row_newbcast:10 row_mask:0xf bank_mask:0xf
    s_waitcnt vmcnt(4)
    v_lshlrev_b32 v26, 16, v76
    v_and_b32 v27, s9, v76
    v_lshlrev_b32 v28, 16, v77
    v_and_b32 v29, s9, v77
    v_lshlrev_b32 v30, 16, v78
    v_and_b32 v31, s9, v78
    v_lshlrev_b32 v32, 16, v79
    v_and_b32 v33, s9, v79
    v_fmac_f32_dpp v18, v9, v26 row_newbcast:11 row_mask:0xf bank_mask:0xf
    v_fmac_f32_dpp v19, v9, v27 row_newbcast:11 row_mask:0xf bank_mask:0xf
    v_fmac_f32_dpp v20, v9, v28 row_newbcast:11 row_mask:0xf bank_mask:0xf
    v_fmac_f32_dpp v21, v9, v29 row_newbcast:11 row_mask:0xf bank_mask:0xf
    v_fmac_f32_dpp v22, v9, v30 row_newbcast:11 row_mask:0xf bank_mask:0xf
    v_fmac_f32_dpp v23, v9, v31 row_newbcast:11 row_mask:0xf bank_mask:0xf
    v_fmac_f32_dpp v24, v9, v32 row_newbcast:11 row_mask:0xf bank_mask:0xf
    v_fmac_f32_dpp v25, v9, v33 row_newbcast:11 row_mask:0xf bank_mask:0xf
    s_waitcnt vmcnt(3)
    v_lshlrev_b32 v26, 16, v80
    v_and_b32 v27, s9, v80
    v_lshlrev_b32 v28, 16, v81
    v_and_b32 v29, s9, v81
    v_lshlrev_b32 v30, 16, v82
    v_and_b32 v31, s9, v82
    v_lshlrev_b32 v32, 16, v83
    v_and_b32 v33, s9, v83
    v_fmac_f32_dpp v18, v9, v26 row_newbcast:12 row_mask:0xf bank_mask:0xf
    v_fmac_f32_dpp v19, v9, v27 row_newbcast:12 row_mask:0xf bank_mask:0xf
    v_fmac_f32_dpp v20, v9, v28 row_newbcast:12 row_mask:0xf bank_mask:0xf
    v_fmac_f32_dpp v21, v9, v29 row_newbcast:12 row_mask:0xf bank_mask:0xf
    v_fmac_f32_dpp v22, v9, v30 row_newbcast:12 row_mask:0xf bank_mask:0xf
    v_fmac_f32_dpp v23, v9, v31 row_newbcast:12 row_mask:0xf bank_mask:0xf
    v_fmac_f32_dpp v24, v9, v32 row_newbcast:12 row_mask:0xf bank_mask:0xf
    v_fmac_f32_dpp v25, v9, v33 row_newbcast:12 row_mask:0xf bank_mask:0xf
    s_waitcnt vmcnt(2)
    v_lshlrev_b32 v26, 16, v84
    v_and_b32 v27, s9, v84
    v_lshlrev_b32 v28, 16, v85
    v_and_b32 v29, s9, v85
    v_lshlrev_b32 v30, 16, v86
    v_and_b32 v31, s9, v86
    v_lshlrev_b32 v32, 16, v87
    v_and_b32 v33, s9, v87
    v_fmac_f32_dpp v18, v9, v26 row_newbcast:13 row_mask:0xf bank_mask:0xf
    v_fmac_f32_dpp v19, v9, v27 row_newbcast:13 row_mask:0xf bank_mask:0xf
    v_fmac_f32_dpp v20, v9, v28 row_newbcast:13 row_mask:0xf bank_mask:0xf
    v_fmac_f32_dpp v21, v9, v29 row_newbcast:13 row_mask:0xf bank_mask:0xf
    v_fmac_f32_dpp v22, v9, v30 row_newbcast:13 row_mask:0xf bank_mask:0xf
    v_fmac_f32_dpp v23, v9, v31 row_newbcast:13 row_mask:0xf bank_mask:0xf
    v_fmac_f32_dpp v24, v9, v32 row_newbcast:13 row_mask:0xf bank_mask:0xf
    v_fmac_f32_dpp v25, v9, v33 row_newbcast:13 row_mask:0xf bank_mask:0xf
    s_waitcnt vmcnt(1)
    v_lshlrev_b32 v26, 16, v88
    v_and_b32 v27, s9, v88
    v_lshlrev_b32 v28, 16, v89
    v_and_b32 v29, s9, v89
    v_lshlrev_b32 v30, 16, v90
    v_and_b32 v31, s9, v90
    v_lshlrev_b32 v32, 16, v91
    v_and_b32 v33, s9, v91
    v_fmac_f32_dpp v18, v9, v26 row_newbcast:14 row_mask:0xf bank_mask:0xf
    v_fmac_f32_dpp v19, v9, v27 row_newbcast:14 row_mask:0xf bank_mask:0xf
    v_fmac_f32_dpp v20, v9, v28 row_newbcast:14 row_mask:0xf bank_mask:0xf
    v_fmac_f32_dpp v21, v9, v29 row_newbcast:14 row_mask:0xf bank_mask:0xf
    v_fmac_f32_dpp v22, v9, v30 row_newbcast:14 row_mask:0xf bank_mask:0xf
    v_fmac_f32_dpp v23, v9, v31 row_newbcast:14 row_mask:0xf bank_mask:0xf
    v_fmac_f32_dpp v24, v9, v32 row_newbcast:14 row_mask:0xf bank_mask:0xf
    v_fmac_f32_dpp v25, v9, v33 row_newbcast:14 row_mask:0xf bank_mask:0xf
    s_waitcnt vmcnt(0)
    v_lshlrev_b32 v26, 16, v92
    v_and_b32 v27, s9, v92
    v_lshlrev_b32 v28, 16, v93
    v_and_b32 v29, s9, v93
    v_lshlrev_b32 v30, 16, v94
    v_and_b32 v31, s9, v94
    v_lshlrev_b32 v32, 16, v95
    v_and_b32 v33, s9, v95
    v_fmac_f32_dpp v18, v9, v26 row_newbcast:15 row_mask:0xf bank_mask:0xf
    v_fmac_f32_dpp v19, v9, v27 row_newbcast:15 row_mask:0xf bank_mask:0xf
    v_fmac_f32_dpp v20, v9, v28 row_newbcast:15 row_mask:0xf bank_mask:0xf
    v_fmac_f32_dpp v21, v9, v29 row_newbcast:15 row_mask:0xf bank_mask:0xf
    v_fmac_f32_dpp v22, v9, v30 row_newbcast:15 row_mask:0xf bank_mask:0xf
    v_fmac_f32_dpp v23, v9, v31 row_newbcast:15 row_mask:0xf bank_mask:0xf
    v_fmac_f32_dpp v24, v9, v32 row_newbcast:15 row_mask:0xf bank_mask:0xf
    v_fmac_f32_dpp v25, v9, v33 row_newbcast:15 row_mask:0xf bank_mask:0xf
    s_nop 1
    v_permlane32_swap_b32 v18, v22
    v_permlane32_swap_b32 v19, v23
    v_permlane32_swap_b32 v20, v24
    v_permlane32_swap_b32 v21, v25
    s_nop 0
    v_add_f32 v18, v18, v22
    v_add_f32 v19, v19, v23
    v_add_f32 v20, v20, v24
    v_add_f32 v21, v21, v25
    s_nop 1
    v_permlane16_swap_b32 v18, v20
    v_permlane16_swap_b32 v19, v21
    s_nop 0
    v_add_f32 v18, v18, v20
    v_add_f32 v19, v19, v21
    v_and_b32 v3, 15, v1
    v_lshlrev_b32 v3, 5, v3
    v_lshrrev_b32 v4, 5, v1
    v_lshl_add_u32 v3, v4, 4, v3
    v_bfe_u32 v4, v1, 4, 1
    v_lshl_add_u32 v3, v4, 3, v3
    ds_add_f32 v3, v18 offset:0
    ds_add_f32 v3, v19 offset:4
    s_waitcnt lgkmcnt(0)
    v_mov_b32 v4, 1
    s_mov_b64 exec, 1
    ds_add_u32 v5, v4 offset:1044
    s_mov_b64 exec, -1
    s_cmp_lg_u32 s7, 0
    s_cbranch_scc1 L_SVC_DMA
    s_cmp_lg_u32 s2, 0
    s_cbranch_scc1 L_NOZERO
    s_add_u32 s68, s38, 393216
    s_addc_u32 s69, s39, 0
    v_mov_b32 v56, 0
    v_mov_b32 v57, 0
    v_mov_b32 v58, 0
    v_mov_b32 v59, 0
    v_mov_b32 v4, v2
    global_store_dwordx4 v4, v[56:59], s[68:69] offset:0 sc1
    global_store_dwordx4 v4, v[56:59], s[68:69] offset:1024 sc1
    global_store_dwordx4 v4, v[56:59], s[68:69] offset:2048 sc1
    global_store_dwordx4 v4, v[56:59], s[68:69] offset:3072 sc1
    v_add_u32 v4, 4096, v4
    global_store_dwordx4 v4, v[56:59], s[68:69] offset:0 sc1
    global_store_dwordx4 v4, v[56:59], s[68:69] offset:1024 sc1
    global_store_dwordx4 v4, v[56:59], s[68:69] offset:2048 sc1
    global_store_dwordx4 v4, v[56:59], s[68:69] offset:3072 sc1
    v_add_u32 v4, 4096, v4
    global_store_dwordx4 v4, v[56:59], s[68:69] offset:0 sc1
    global_store_dwordx4 v4, v[56:59], s[68:69] offset:1024 sc1
    global_store_dwordx4 v4, v[56:59], s[68:69] offset:2048 sc1
    global_store_dwordx4 v4, v[56:59], s[68:69] offset:3072 sc1
    v_add_u32 v4, 4096, v4
    global_store_dwordx4 v4, v[56:59], s[68:69] offset:0 sc1
    global_store_dwordx4 v4, v[56:59], s[68:69] offset:1024 sc1
    global_store_dwordx4 v4, v[56:59], s[68:69] offset:2048 sc1
    global_store_dwordx4 v4, v[56:59], s[68:69] offset:3072 sc1
    s_waitcnt vmcnt(0)
    v_mov_b32 v4, 1
    s_mov_b64 exec, 1
    global_atomic_add v5, v4, s[36:37] offset:132
    s_mov_b64 exec, -1
L_NOZERO:
    v_lshrrev_b32 v3, 3, v1
    v_and_b32 v4, 7, v1
    v_min_u32 v4, 6, v4
    v_mul_u32_u24 v58, 3584, v3
    v_lshl_add_u32 v58, v4, 4, v58
    s_lshl_b32 s60, s4, 6
    s_mul_i32 s60, s60, 3584
    s_mul_i32 s61, s3, 112
    s_add_u32 s60, s60, s61
    s_add_u32 s68, s28, s60
    s_addc_u32 s69, s29, 0
    s_add_u32 s70, s30, s60
    s_addc_u32 s71, s31, 0
    global_load_dwordx4 v[64:67], v58, s[68:69]
    global_load_dwordx4 v[68:71], v58, s[70:71]
    v_add_u32 v58, 28672, v58
    global_load_dwordx4 v[72:75], v58, s[68:69]
    global_load_dwordx4 v[76:79], v58, s[70:71]
    v_add_u32 v58, 28672, v58
    global_load_dwordx4 v[80:83], v58, s[68:69]
    global_load_dwordx4 v[84:87], v58, s[70:71]
    v_add_u32 v58, 28672, v58
    global_load_dwordx4 v[88:91], v58, s[68:69]
    global_load_dwordx4 v[92:95], v58, s[70:71]
    v_add_u32 v58, 28672, v58
    global_load_dwordx4 v[96:99], v58, s[68:69]
    global_load_dwordx4 v[100:103], v58, s[70:71]
    v_add_u32 v58, 28672, v58
    global_load_dwordx4 v[104:107], v58, s[68:69]
    global_load_dwordx4 v[108:111], v58, s[70:71]
    v_add_u32 v58, 28672, v58
    global_load_dwordx4 v[112:115], v58, s[68:69]
    global_load_dwordx4 v[116:119], v58, s[70:71]
    v_add_u32 v58, 28672, v58
    global_load_dwordx4 v[120:123], v58, s[68:69]
    global_load_dwordx4 v[124:127], v58, s[70:71]
    v_lshlrev_b32 v3, 2, v3
    s_lshl_b32 s60, s4, 8
    v_add_u32 v3, s60, v3
    ds_read_b32 v10, v3 offset:4096
    ds_read_b32 v11, v3 offset:4128
    ds_read_b32 v12, v3 offset:4160
    ds_read_b32 v13, v3 offset:4192
    ds_read_b32 v14, v3 offset:4224
    ds_read_b32 v15, v3 offset:4256
    ds_read_b32 v16, v3 offset:4288
    ds_read_b32 v17, v3 offset:4320
    v_mov_b32 v34, 0
    v_mov_b32 v35, 0
    v_mov_b32 v36, 0
    v_mov_b32 v37, 0
    v_mov_b32 v38, 0
    v_mov_b32 v39, 0
    v_mov_b32 v40, 0
    v_mov_b32 v41, 0
    v_mov_b32 v42, 0
    v_mov_b32 v43, 0
    v_mov_b32 v44, 0
    v_mov_b32 v45, 0
    v_mov_b32 v46, 0
    v_mov_b32 v47, 0
    v_mov_b32 v48, 0
    v_mov_b32 v49, 0
    s_waitcnt lgkmcnt(0)
    s_waitcnt vmcnt(14)
    v_lshlrev_b32 v26, 16, v64
    v_and_b32 v27, s9, v64
    v_lshlrev_b32 v28, 16, v65
    v_and_b32 v29, s9, v65
    v_lshlrev_b32 v30, 16, v66
    v_and_b32 v31, s9, v66
    v_lshlrev_b32 v32, 16, v67
    v_and_b32 v33, s9, v67
    v_fmac_f32 v34, v26, v10
    v_fmac_f32 v35, v27, v10
    v_fmac_f32 v36, v28, v10
    v_fmac_f32 v37, v29, v10
    v_fmac_f32 v38, v30, v10
    v_fmac_f32 v39, v31, v10
    v_fmac_f32 v40, v32, v10
    v_fmac_f32 v41, v33, v10
    v_lshlrev_b32 v26, 16, v68
    v_and_b32 v27, s9, v68
    v_lshlrev_b32 v28, 16, v69
    v_and_b32 v29, s9, v69
    v_lshlrev_b32 v30, 16, v70
    v_and_b32 v31, s9, v70
    v_lshlrev_b32 v32, 16, v71
    v_and_b32 v33, s9, v71
    v_fmac_f32 v42, v26, v10
    v_fmac_f32 v43, v27, v10
    v_fmac_f32 v44, v28, v10
    v_fmac_f32 v45, v29, v10
    v_fmac_f32 v46, v30, v10
    v_fmac_f32 v47, v31, v10
    v_fmac_f32 v48, v32, v10
    v_fmac_f32 v49, v33, v10
    s_waitcnt vmcnt(12)
    v_lshlrev_b32 v26, 16, v72
    v_and_b32 v27, s9, v72
    v_lshlrev_b32 v28, 16, v73
    v_and_b32 v29, s9, v73
    v_lshlrev_b32 v30, 16, v74
    v_and_b32 v31, s9, v74
    v_lshlrev_b32 v32, 16, v75
    v_and_b32 v33, s9, v75
    v_fmac_f32 v34, v26, v11
    v_fmac_f32 v35, v27, v11
    v_fmac_f32 v36, v28, v11
    v_fmac_f32 v37, v29, v11
    v_fmac_f32 v38, v30, v11
    v_fmac_f32 v39, v31, v11
    v_fmac_f32 v40, v32, v11
    v_fmac_f32 v41, v33, v11
    v_lshlrev_b32 v26, 16, v76
    v_and_b32 v27, s9, v76
    v_lshlrev_b32 v28, 16, v77
    v_and_b32 v29, s9, v77
    v_lshlrev_b32 v30, 16, v78
    v_and_b32 v31, s9, v78
    v_lshlrev_b32 v32, 16, v79
    v_and_b32 v33, s9, v79
    v_fmac_f32 v42, v26, v11
    v_fmac_f32 v43, v27, v11
    v_fmac_f32 v44, v28, v11
    v_fmac_f32 v45, v29, v11
    v_fmac_f32 v46, v30, v11
    v_fmac_f32 v47, v31, v11
    v_fmac_f32 v48, v32, v11
    v_fmac_f32 v49, v33, v11
    s_waitcnt vmcnt(10)
    v_lshlrev_b32 v26, 16, v80
    v_and_b32 v27, s9, v80
    v_lshlrev_b32 v28, 16, v81
    v_and_b32 v29, s9, v81
    v_lshlrev_b32 v30, 16, v82
    v_and_b32 v31, s9, v82
    v_lshlrev_b32 v32, 16, v83
    v_and_b32 v33, s9, v83
    v_fmac_f32 v34, v26, v12
    v_fmac_f32 v35, v27, v12
    v_fmac_f32 v36, v28, v12
    v_fmac_f32 v37, v29, v12
    v_fmac_f32 v38, v30, v12
    v_fmac_f32 v39, v31, v12
    v_fmac_f32 v40, v32, v12
    v_fmac_f32 v41, v33, v12
    v_lshlrev_b32 v26, 16, v84
    v_and_b32 v27, s9, v84
    v_lshlrev_b32 v28, 16, v85
    v_and_b32 v29, s9, v85
    v_lshlrev_b32 v30, 16, v86
    v_and_b32 v31, s9, v86
    v_lshlrev_b32 v32, 16, v87
    v_and_b32 v33, s9, v87
    v_fmac_f32 v42, v26, v12
    v_fmac_f32 v43, v27, v12
    v_fmac_f32 v44, v28, v12
    v_fmac_f32 v45, v29, v12
    v_fmac_f32 v46, v30, v12
    v_fmac_f32 v47, v31, v12
    v_fmac_f32 v48, v32, v12
    v_fmac_f32 v49, v33, v12
    s_waitcnt vmcnt(8)
    v_lshlrev_b32 v26, 16, v88
    v_and_b32 v27, s9, v88
    v_lshlrev_b32 v28, 16, v89
    v_and_b32 v29, s9, v89
    v_lshlrev_b32 v30, 16, v90
    v_and_b32 v31, s9, v90
    v_lshlrev_b32 v32, 16, v91
    v_and_b32 v33, s9, v91
    v_fmac_f32 v34, v26, v13
    v_fmac_f32 v35, v27, v13
    v_fmac_f32 v36, v28, v13
    v_fmac_f32 v37, v29, v13
    v_fmac_f32 v38, v30, v13
    v_fmac_f32 v39, v31, v13
    v_fmac_f32 v40, v32, v13
    v_fmac_f32 v41, v33, v13
    v_lshlrev_b32 v26, 16, v92
    v_and_b32 v27, s9, v92
    v_lshlrev_b32 v28, 16, v93
    v_and_b32 v29, s9, v93
    v_lshlrev_b32 v30, 16, v94
    v_and_b32 v31, s9, v94
    v_lshlrev_b32 v32, 16, v95
    v_and_b32 v33, s9, v95
    v_fmac_f32 v42, v26, v13
    v_fmac_f32 v43, v27, v13
    v_fmac_f32 v44, v28, v13
    v_fmac_f32 v45, v29, v13
    v_fmac_f32 v46, v30, v13
    v_fmac_f32 v47, v31, v13
    v_fmac_f32 v48, v32, v13
    v_fmac_f32 v49, v33, v13
    s_waitcnt vmcnt(6)
    v_lshlrev_b32 v26, 16, v96
    v_and_b32 v27, s9, v96
    v_lshlrev_b32 v28, 16, v97
    v_and_b32 v29, s9, v97
    v_lshlrev_b32 v30, 16, v98
    v_and_b32 v31, s9, v98
    v_lshlrev_b32 v32, 16, v99
    v_and_b32 v33, s9, v99
    v_fmac_f32 v34, v26, v14
    v_fmac_f32 v35, v27, v14
    v_fmac_f32 v36, v28, v14
    v_fmac_f32 v37, v29, v14
    v_fmac_f32 v38, v30, v14
    v_fmac_f32 v39, v31, v14
    v_fmac_f32 v40, v32, v14
    v_fmac_f32 v41, v33, v14
    v_lshlrev_b32 v26, 16, v100
    v_and_b32 v27, s9, v100
    v_lshlrev_b32 v28, 16, v101
    v_and_b32 v29, s9, v101
    v_lshlrev_b32 v30, 16, v102
    v_and_b32 v31, s9, v102
    v_lshlrev_b32 v32, 16, v103
    v_and_b32 v33, s9, v103
    v_fmac_f32 v42, v26, v14
    v_fmac_f32 v43, v27, v14
    v_fmac_f32 v44, v28, v14
    v_fmac_f32 v45, v29, v14
    v_fmac_f32 v46, v30, v14
    v_fmac_f32 v47, v31, v14
    v_fmac_f32 v48, v32, v14
    v_fmac_f32 v49, v33, v14
    s_waitcnt vmcnt(4)
    v_lshlrev_b32 v26, 16, v104
    v_and_b32 v27, s9, v104
    v_lshlrev_b32 v28, 16, v105
    v_and_b32 v29, s9, v105
    v_lshlrev_b32 v30, 16, v106
    v_and_b32 v31, s9, v106
    v_lshlrev_b32 v32, 16, v107
    v_and_b32 v33, s9, v107
    v_fmac_f32 v34, v26, v15
    v_fmac_f32 v35, v27, v15
    v_fmac_f32 v36, v28, v15
    v_fmac_f32 v37, v29, v15
    v_fmac_f32 v38, v30, v15
    v_fmac_f32 v39, v31, v15
    v_fmac_f32 v40, v32, v15
    v_fmac_f32 v41, v33, v15
    v_lshlrev_b32 v26, 16, v108
    v_and_b32 v27, s9, v108
    v_lshlrev_b32 v28, 16, v109
    v_and_b32 v29, s9, v109
    v_lshlrev_b32 v30, 16, v110
    v_and_b32 v31, s9, v110
    v_lshlrev_b32 v32, 16, v111
    v_and_b32 v33, s9, v111
    v_fmac_f32 v42, v26, v15
    v_fmac_f32 v43, v27, v15
    v_fmac_f32 v44, v28, v15
    v_fmac_f32 v45, v29, v15
    v_fmac_f32 v46, v30, v15
    v_fmac_f32 v47, v31, v15
    v_fmac_f32 v48, v32, v15
    v_fmac_f32 v49, v33, v15
    s_waitcnt vmcnt(2)
    v_lshlrev_b32 v26, 16, v112
    v_and_b32 v27, s9, v112
    v_lshlrev_b32 v28, 16, v113
    v_and_b32 v29, s9, v113
    v_lshlrev_b32 v30, 16, v114
    v_and_b32 v31, s9, v114
    v_lshlrev_b32 v32, 16, v115
    v_and_b32 v33, s9, v115
    v_fmac_f32 v34, v26, v16
    v_fmac_f32 v35, v27, v16
    v_fmac_f32 v36, v28, v16
    v_fmac_f32 v37, v29, v16
    v_fmac_f32 v38, v30, v16
    v_fmac_f32 v39, v31, v16
    v_fmac_f32 v40, v32, v16
    v_fmac_f32 v41, v33, v16
    v_lshlrev_b32 v26, 16, v116
    v_and_b32 v27, s9, v116
    v_lshlrev_b32 v28, 16, v117
    v_and_b32 v29, s9, v117
    v_lshlrev_b32 v30, 16, v118
    v_and_b32 v31, s9, v118
    v_lshlrev_b32 v32, 16, v119
    v_and_b32 v33, s9, v119
    v_fmac_f32 v42, v26, v16
    v_fmac_f32 v43, v27, v16
    v_fmac_f32 v44, v28, v16
    v_fmac_f32 v45, v29, v16
    v_fmac_f32 v46, v30, v16
    v_fmac_f32 v47, v31, v16
    v_fmac_f32 v48, v32, v16
    v_fmac_f32 v49, v33, v16
    s_waitcnt vmcnt(0)
    v_lshlrev_b32 v26, 16, v120
    v_and_b32 v27, s9, v120
    v_lshlrev_b32 v28, 16, v121
    v_and_b32 v29, s9, v121
    v_lshlrev_b32 v30, 16, v122
    v_and_b32 v31, s9, v122
    v_lshlrev_b32 v32, 16, v123
    v_and_b32 v33, s9, v123
    v_fmac_f32 v34, v26, v17
    v_fmac_f32 v35, v27, v17
    v_fmac_f32 v36, v28, v17
    v_fmac_f32 v37, v29, v17
    v_fmac_f32 v38, v30, v17
    v_fmac_f32 v39, v31, v17
    v_fmac_f32 v40, v32, v17
    v_fmac_f32 v41, v33, v17
    v_lshlrev_b32 v26, 16, v124
    v_and_b32 v27, s9, v124
    v_lshlrev_b32 v28, 16, v125
    v_and_b32 v29, s9, v125
    v_lshlrev_b32 v30, 16, v126
    v_and_b32 v31, s9, v126
    v_lshlrev_b32 v32, 16, v127
    v_and_b32 v33, s9, v127
    v_fmac_f32 v42, v26, v17
    v_fmac_f32 v43, v27, v17
    v_fmac_f32 v44, v28, v17
    v_fmac_f32 v45, v29, v17
    v_fmac_f32 v46, v30, v17
    v_fmac_f32 v47, v31, v17
    v_fmac_f32 v48, v32, v17
    v_fmac_f32 v49, v33, v17
    s_nop 1
    v_permlane32_swap_b32 v34, v42
    v_permlane32_swap_b32 v35, v43
    v_permlane32_swap_b32 v36, v44
    v_permlane32_swap_b32 v37, v45
    v_permlane32_swap_b32 v38, v46
    v_permlane32_swap_b32 v39, v47
    v_permlane32_swap_b32 v40, v48
    v_permlane32_swap_b32 v41, v49
    s_nop 0
    v_add_f32 v34, v34, v42
    v_add_f32 v35, v35, v43
    v_add_f32 v36, v36, v44
    v_add_f32 v37, v37, v45
    v_add_f32 v38, v38, v46
    v_add_f32 v39, v39, v47
    v_add_f32 v40, v40, v48
    v_add_f32 v41, v41, v49
    s_nop 1
    v_permlane16_swap_b32 v34, v38
    v_permlane16_swap_b32 v35, v39
    v_permlane16_swap_b32 v36, v40
    v_permlane16_swap_b32 v37, v41
    s_nop 0
    v_add_f32 v34, v34, v38
    v_add_f32 v35, v35, v39
    v_add_f32 v36, v36, v40
    v_add_f32 v37, v37, v41
    s_nop 1
    v_add_f32_dpp v34, v34, v34 row_ror:8 row_mask:0xf bank_mask:0x3
    v_add_f32_dpp v34, v36, v36 row_ror:8 row_mask:0xf bank_mask:0xc
    v_add_f32_dpp v35, v35, v35 row_ror:8 row_mask:0xf bank_mask:0x3
    v_add_f32_dpp v35, v37, v37 row_ror:8 row_mask:0xf bank_mask:0xc
    v_and_b32 v3, 7, v1
    v_lshlrev_b32 v3, 5, v3
    v_lshrrev_b32 v4, 5, v1
    v_lshl_add_u32 v3, v4, 8, v3
    v_bfe_u32 v4, v1, 4, 1
    v_lshl_add_u32 v3, v4, 4, v3
    v_bfe_u32 v4, v1, 3, 1
    v_lshl_add_u32 v3, v4, 3, v3
    s_lshl_b32 s60, s3, 12
    s_lshl_b32 s61, s4, 9
    s_add_u32 s60, s60, s61
    s_add_u32 s60, s60, 32768
    s_add_u32 s68, s38, s60
    s_addc_u32 s69, s39, 0
    global_store_dwordx2 v3, v[34:35], s[68:69] sc1
    s_mul_i32 s60, s3, 56
    s_mul_i32 s61, s4, 7
    s_add_u32 s60, s60, s61
    s_lshl_b32 s60, s60, 10
    s_add_u32 s68, s32, s60
    s_addc_u32 s69, s33, 0
    global_load_dwordx4 v[64:67], v2, s[68:69] offset:0
    global_load_dwordx4 v[68:71], v2, s[68:69] offset:1024
    global_load_dwordx4 v[72:75], v2, s[68:69] offset:2048
    global_load_dwordx4 v[76:79], v2, s[68:69] offset:3072
    v_add_u32 v4, 4096, v2
    global_load_dwordx4 v[80:83], v4, s[68:69] offset:0
    global_load_dwordx4 v[84:87], v4, s[68:69] offset:1024
    global_load_dwordx4 v[88:91], v4, s[68:69] offset:2048
    s_mov_b32 s6, 0
L_KD:
    ds_read_b32 v4, v5 offset:1052
    s_add_u32 s6, s6, 1
    s_cmp_gt_u32 s6, 0x400000
    s_cbranch_scc1 L_KDOK
    s_waitcnt lgkmcnt(0)
    v_readfirstlane_b32 s60, v4
    s_cmp_ge_u32 s60, 8
    s_cbranch_scc1 L_KDOK
    s_sleep 16
    s_branch L_KD
L_KDOK:
    s_waitcnt lgkmcnt(0)
    v_lshlrev_b32 v3, 3, v1
    ds_read_b64 v[56:57], v3 offset:1088
    s_lshl_b32 s60, s3, 9
    s_lshl_b32 s61, s4, 6
    s_add_u32 s60, s60, s61
    s_add_u32 s68, s38, s60
    s_addc_u32 s69, s39, 0
    s_waitcnt lgkmcnt(0)
    s_mov_b64 exec, 0xff
    global_store_dwordx2 v3, v[56:57], s[68:69] sc1
    s_mov_b64 exec, -1
    v_mov_b32 v4, 1
    s_waitcnt vmcnt(0)
    s_mov_b64 exec, 1
    global_atomic_add v5, v4, s[66:67]
    s_mov_b64 exec, -1
    s_mov_b32 s6, 0
L_PW1:
    ds_read_b32 v4, v5 offset:1040
    s_add_u32 s6, s6, 1
    s_cmp_gt_u32 s6, 0x400000
    s_cbranch_scc1 L_PW1OK
    s_waitcnt lgkmcnt(0)
    v_readfirstlane_b32 s60, v4
    s_cmp_ge_u32 s60, 8
    s_cbranch_scc1 L_PW1OK
    s_sleep 16
    s_branch L_PW1
L_PW1OK:
    s_waitcnt lgkmcnt(0)
    s_mov_b32 s6, 0
L_RPOLL:
    s_add_u32 s6, s6, 1
    s_cmp_gt_u32 s6, 0x20000
    s_cbranch_scc1 L_ROK
    global_load_dword v56, v5, s[66:67] sc1
    global_load_dword v57, v5, s[36:37] offset:132 sc1
    s_waitcnt vmcnt(0)
    v_readfirstlane_b32 s60, v56
    v_readfirstlane_b32 s61, v57
    s_cmp_lg_u32 s60, 8
    s_cbranch_scc1 L_RSLEEP
    s_cmp_lg_u32 s61, 0
    s_cbranch_scc1 L_ROK
L_RSLEEP:
    s_sleep 127
    s_branch L_RPOLL
L_ROK:
    s_lshl_b32 s60, s3, 9
    s_add_u32 s68, s38, s60
    s_addc_u32 s69, s39, 0
    v_lshlrev_b32 v3, 3, v1
    global_load_dwordx2 v[52:53], v3, s[68:69] sc1
    v_lshrrev_b32 v3, 3, v1
    v_and_b32 v4, 7, v1
    v_lshlrev_b32 v3, 9, v3
    v_lshl_add_u32 v3, v4, 2, v3
    s_lshl_b32 s60, s3, 12
    s_mul_i32 s61, s4, 28
    s_add_u32 s60, s60, s61
    s_add_u32 s60, s60, 32768
    s_add_u32 s68, s38, s60
    s_addc_u32 s69, s39, 0
    global_load_dword v62, v3, s[68:69] sc1
    global_load_dword v63, v3, s[68:69] offset:256 sc1
    s_waitcnt vmcnt(0)
    v_mov_b32 v56, v52
    s_nop 1
    v_max_f32_dpp v56, v56, v56 row_ror:8 row_mask:0xf bank_mask:0xf
    s_nop 1
    v_max_f32_dpp v56, v56, v56 row_ror:4 row_mask:0xf bank_mask:0xf
    s_nop 1
    v_max_f32_dpp v56, v56, v56 row_ror:2 row_mask:0xf bank_mask:0xf
    s_nop 1
    v_max_f32_dpp v56, v56, v56 row_ror:1 row_mask:0xf bank_mask:0xf
    s_nop 0
    v_readlane_b32 s60, v56, 0
    v_readlane_b32 s61, v56, 16
    v_readlane_b32 s62, v56, 32
    v_readlane_b32 s63, v56, 48
    s_nop 1
    v_mov_b32 v56, s60
    v_max_f32 v56, s61, v56
    v_max_f32 v56, s62, v56
    v_max_f32 v56, s63, v56
    v_sub_f32 v57, v52, v56
    v_exp_f32 v57, v57
    s_nop 0
    v_mul_f32 v57, v57, v53
    s_nop 1
    v_add_f32_dpp v57, v57, v57 row_ror:8 row_mask:0xf bank_mask:0xf
    s_nop 1
    v_add_f32_dpp v57, v57, v57 row_ror:4 row_mask:0xf bank_mask:0xf
    s_nop 1
    v_add_f32_dpp v57, v57, v57 row_ror:2 row_mask:0xf bank_mask:0xf
    s_nop 1
    v_add_f32_dpp v57, v57, v57 row_ror:1 row_mask:0xf bank_mask:0xf
    s_nop 0
    v_readlane_b32 s60, v57, 0
    v_readlane_b32 s61, v57, 16
    v_readlane_b32 s62, v57, 32
    v_readlane_b32 s63, v57, 48
    s_nop 1
    v_mov_b32 v57, s60
    v_add_f32 v57, s61, v57
    v_add_f32 v57, s62, v57
    v_add_f32 v57, s63, v57
    v_rcp_f32 v57, v57
    s_nop 1
    v_add_f32_dpp v62, v62, v62 row_ror:8 row_mask:0xf bank_mask:0xf
    v_add_f32_dpp v63, v63, v63 row_ror:8 row_mask:0xf bank_mask:0xf
    v_mov_b32 v60, v62
    v_mov_b32 v61, v63
    s_nop 1
    v_permlane16_swap_b32 v62, v60
    v_permlane16_swap_b32 v63, v61
    s_nop 0
    v_add_f32 v62, v62, v60
    v_add_f32 v63, v63, v61
    v_mov_b32 v60, v62
    v_mov_b32 v61, v63
    s_nop 1
    v_permlane32_swap_b32 v62, v60
    v_permlane32_swap_b32 v63, v61
    s_nop 0
    v_add_f32 v62, v62, v60
    v_add_f32 v63, v63, v61
    v_mul_f32 v62, 0xbfb8aa3b, v62
    v_exp_f32 v62, v62
    s_nop 0
    v_add_f32 v62, 1.0, v62
    v_rcp_f32 v62, v62
    s_nop 0
    v_mul_f32 v62, v62, v63
    v_mov_b32 v18, 0
    v_mov_b32 v19, 0
    v_mov_b32 v20, 0
    v_mov_b32 v21, 0
    v_mov_b32 v22, 0
    v_mov_b32 v23, 0
    v_mov_b32 v24, 0
    v_mov_b32 v25, 0
    v_lshlrev_b32 v26, 16, v64
    v_and_b32 v27, s9, v64
    v_lshlrev_b32 v28, 16, v65
    v_and_b32 v29, s9, v65
    v_lshlrev_b32 v30, 16, v66
    v_and_b32 v31, s9, v66
    v_lshlrev_b32 v32, 16, v67
    v_and_b32 v33, s9, v67
    v_fmac_f32_dpp v18, v62, v26 row_newbcast:0 row_mask:0xf bank_mask:0xf
    v_fmac_f32_dpp v19, v62, v27 row_newbcast:0 row_mask:0xf bank_mask:0xf
    v_fmac_f32_dpp v20, v62, v28 row_newbcast:0 row_mask:0xf bank_mask:0xf
    v_fmac_f32_dpp v21, v62, v29 row_newbcast:0 row_mask:0xf bank_mask:0xf
    v_fmac_f32_dpp v22, v62, v30 row_newbcast:0 row_mask:0xf bank_mask:0xf
    v_fmac_f32_dpp v23, v62, v31 row_newbcast:0 row_mask:0xf bank_mask:0xf
    v_fmac_f32_dpp v24, v62, v32 row_newbcast:0 row_mask:0xf bank_mask:0xf
    v_fmac_f32_dpp v25, v62, v33 row_newbcast:0 row_mask:0xf bank_mask:0xf
    v_lshlrev_b32 v26, 16, v68
    v_and_b32 v27, s9, v68
    v_lshlrev_b32 v28, 16, v69
    v_and_b32 v29, s9, v69
    v_lshlrev_b32 v30, 16, v70
    v_and_b32 v31, s9, v70
    v_lshlrev_b32 v32, 16, v71
    v_and_b32 v33, s9, v71
    v_fmac_f32_dpp v18, v62, v26 row_newbcast:1 row_mask:0xf bank_mask:0xf
    v_fmac_f32_dpp v19, v62, v27 row_newbcast:1 row_mask:0xf bank_mask:0xf
    v_fmac_f32_dpp v20, v62, v28 row_newbcast:1 row_mask:0xf bank_mask:0xf
    v_fmac_f32_dpp v21, v62, v29 row_newbcast:1 row_mask:0xf bank_mask:0xf
    v_fmac_f32_dpp v22, v62, v30 row_newbcast:1 row_mask:0xf bank_mask:0xf
    v_fmac_f32_dpp v23, v62, v31 row_newbcast:1 row_mask:0xf bank_mask:0xf
    v_fmac_f32_dpp v24, v62, v32 row_newbcast:1 row_mask:0xf bank_mask:0xf
    v_fmac_f32_dpp v25, v62, v33 row_newbcast:1 row_mask:0xf bank_mask:0xf
    v_lshlrev_b32 v26, 16, v72
    v_and_b32 v27, s9, v72
    v_lshlrev_b32 v28, 16, v73
    v_and_b32 v29, s9, v73
    v_lshlrev_b32 v30, 16, v74
    v_and_b32 v31, s9, v74
    v_lshlrev_b32 v32, 16, v75
    v_and_b32 v33, s9, v75
    v_fmac_f32_dpp v18, v62, v26 row_newbcast:2 row_mask:0xf bank_mask:0xf
    v_fmac_f32_dpp v19, v62, v27 row_newbcast:2 row_mask:0xf bank_mask:0xf
    v_fmac_f32_dpp v20, v62, v28 row_newbcast:2 row_mask:0xf bank_mask:0xf
    v_fmac_f32_dpp v21, v62, v29 row_newbcast:2 row_mask:0xf bank_mask:0xf
    v_fmac_f32_dpp v22, v62, v30 row_newbcast:2 row_mask:0xf bank_mask:0xf
    v_fmac_f32_dpp v23, v62, v31 row_newbcast:2 row_mask:0xf bank_mask:0xf
    v_fmac_f32_dpp v24, v62, v32 row_newbcast:2 row_mask:0xf bank_mask:0xf
    v_fmac_f32_dpp v25, v62, v33 row_newbcast:2 row_mask:0xf bank_mask:0xf
    v_lshlrev_b32 v26, 16, v76
    v_and_b32 v27, s9, v76
    v_lshlrev_b32 v28, 16, v77
    v_and_b32 v29, s9, v77
    v_lshlrev_b32 v30, 16, v78
    v_and_b32 v31, s9, v78
    v_lshlrev_b32 v32, 16, v79
    v_and_b32 v33, s9, v79
    v_fmac_f32_dpp v18, v62, v26 row_newbcast:3 row_mask:0xf bank_mask:0xf
    v_fmac_f32_dpp v19, v62, v27 row_newbcast:3 row_mask:0xf bank_mask:0xf
    v_fmac_f32_dpp v20, v62, v28 row_newbcast:3 row_mask:0xf bank_mask:0xf
    v_fmac_f32_dpp v21, v62, v29 row_newbcast:3 row_mask:0xf bank_mask:0xf
    v_fmac_f32_dpp v22, v62, v30 row_newbcast:3 row_mask:0xf bank_mask:0xf
    v_fmac_f32_dpp v23, v62, v31 row_newbcast:3 row_mask:0xf bank_mask:0xf
    v_fmac_f32_dpp v24, v62, v32 row_newbcast:3 row_mask:0xf bank_mask:0xf
    v_fmac_f32_dpp v25, v62, v33 row_newbcast:3 row_mask:0xf bank_mask:0xf
    v_lshlrev_b32 v26, 16, v80
    v_and_b32 v27, s9, v80
    v_lshlrev_b32 v28, 16, v81
    v_and_b32 v29, s9, v81
    v_lshlrev_b32 v30, 16, v82
    v_and_b32 v31, s9, v82
    v_lshlrev_b32 v32, 16, v83
    v_and_b32 v33, s9, v83
    v_fmac_f32_dpp v18, v62, v26 row_newbcast:4 row_mask:0xf bank_mask:0xf
    v_fmac_f32_dpp v19, v62, v27 row_newbcast:4 row_mask:0xf bank_mask:0xf
    v_fmac_f32_dpp v20, v62, v28 row_newbcast:4 row_mask:0xf bank_mask:0xf
    v_fmac_f32_dpp v21, v62, v29 row_newbcast:4 row_mask:0xf bank_mask:0xf
    v_fmac_f32_dpp v22, v62, v30 row_newbcast:4 row_mask:0xf bank_mask:0xf
    v_fmac_f32_dpp v23, v62, v31 row_newbcast:4 row_mask:0xf bank_mask:0xf
    v_fmac_f32_dpp v24, v62, v32 row_newbcast:4 row_mask:0xf bank_mask:0xf
    v_fmac_f32_dpp v25, v62, v33 row_newbcast:4 row_mask:0xf bank_mask:0xf
    v_lshlrev_b32 v26, 16, v84
    v_and_b32 v27, s9, v84
    v_lshlrev_b32 v28, 16, v85
    v_and_b32 v29, s9, v85
    v_lshlrev_b32 v30, 16, v86
    v_and_b32 v31, s9, v86
    v_lshlrev_b32 v32, 16, v87
    v_and_b32 v33, s9, v87
    v_fmac_f32_dpp v18, v62, v26 row_newbcast:5 row_mask:0xf bank_mask:0xf
    v_fmac_f32_dpp v19, v62, v27 row_newbcast:5 row_mask:0xf bank_mask:0xf
    v_fmac_f32_dpp v20, v62, v28 row_newbcast:5 row_mask:0xf bank_mask:0xf
    v_fmac_f32_dpp v21, v62, v29 row_newbcast:5 row_mask:0xf bank_mask:0xf
    v_fmac_f32_dpp v22, v62, v30 row_newbcast:5 row_mask:0xf bank_mask:0xf
    v_fmac_f32_dpp v23, v62, v31 row_newbcast:5 row_mask:0xf bank_mask:0xf
    v_fmac_f32_dpp v24, v62, v32 row_newbcast:5 row_mask:0xf bank_mask:0xf
    v_fmac_f32_dpp v25, v62, v33 row_newbcast:5 row_mask:0xf bank_mask:0xf
    v_lshlrev_b32 v26, 16, v88
    v_and_b32 v27, s9, v88
    v_lshlrev_b32 v28, 16, v89
    v_and_b32 v29, s9, v89
    v_lshlrev_b32 v30, 16, v90
    v_and_b32 v31, s9, v90
    v_lshlrev_b32 v32, 16, v91
    v_and_b32 v33, s9, v91
    v_fmac_f32_dpp v18, v62, v26 row_newbcast:6 row_mask:0xf bank_mask:0xf
    v_fmac_f32_dpp v19, v62, v27 row_newbcast:6 row_mask:0xf bank_mask:0xf
    v_fmac_f32_dpp v20, v62, v28 row_newbcast:6 row_mask:0xf bank_mask:0xf
    v_fmac_f32_dpp v21, v62, v29 row_newbcast:6 row_mask:0xf bank_mask:0xf
    v_fmac_f32_dpp v22, v62, v30 row_newbcast:6 row_mask:0xf bank_mask:0xf
    v_fmac_f32_dpp v23, v62, v31 row_newbcast:6 row_mask:0xf bank_mask:0xf
    v_fmac_f32_dpp v24, v62, v32 row_newbcast:6 row_mask:0xf bank_mask:0xf
    v_fmac_f32_dpp v25, v62, v33 row_newbcast:6 row_mask:0xf bank_mask:0xf
    s_cmp_lg_u32 s2, 0
    s_cbranch_scc1 L_NOX
    v_lshlrev_b32 v3, 5, v1
    ds_read_b128 v[34:37], v3 offset:6144
    ds_read_b128 v[38:41], v3 offset:6160
    s_waitcnt lgkmcnt(0)
    v_add_f32 v18, v18, v34
    v_add_f32 v19, v19, v35
    v_add_f32 v20, v20, v36
    v_add_f32 v21, v21, v37
    v_add_f32 v22, v22, v38
    v_add_f32 v23, v23, v39
    v_add_f32 v24, v24, v40
    v_add_f32 v25, v25, v41
L_NOX:
    v_lshlrev_b32 v3, 5, v1
    ds_write_b128 v3, v[18:21] offset:2048
    ds_write_b128 v3, v[22:25] offset:2064
    v_sub_f32 v58, v52, v56
    v_exp_f32 v58, v58
    v_lshlrev_b32 v3, 2, v1
    s_lshl_b32 s60, s4, 5
    v_subrev_u32 v3, s60, v3
    v_mul_f32 v58, v58, v57
    s_lshl_b32 s60, s4, 3
    s_mov_b32 s70, 0xff
    s_mov_b32 s71, 0
    s_lshl_b64 s[70:71], s[70:71], s60
    s_mov_b64 exec, s[70:71]
    ds_write_b32 v3, v58 offset:1152
    s_mov_b64 exec, -1
    v_mov_b32 v58, v56
    v_mov_b32 v59, v57
    ds_write_b64 v5, v[58:59] offset:1024
    s_waitcnt lgkmcnt(0)
    v_mov_b32 v4, 0x1234
    ds_write_b32 v5, v4 offset:1032
L_SVC_DMA:
    s_mov_b32 s6, 0
L_PW2:
    ds_read_b32 v4, v5 offset:1048
    s_add_u32 s6, s6, 1
    s_cmp_gt_u32 s6, 0x400000
    s_cbranch_scc1 L_PW2OK
    s_waitcnt lgkmcnt(0)
    v_readfirstlane_b32 s60, v4
    s_cmp_ge_u32 s60, 8
    s_cbranch_scc1 L_PW2OK
    s_sleep 8
    s_branch L_PW2
L_PW2OK:
    s_waitcnt lgkmcnt(0)
    s_mov_b32 s56, s24
    s_mov_b32 s57, s25
    s_lshl_b32 s60, s3, 17
    s_lshl_b32 s61, s7, 15
    s_add_u32 s60, s60, s61
    s_add_u32 s61, s61, 24576
    s_mov_b32 s6, 0
L_DMA:
    s_mov_b32 m0, s61
    s_nop 0
    buffer_load_dwordx4 v2, s[56:59], s60 offen lds
    s_add_u32 s60, s60, 1024
    s_add_u32 s61, s61, 1024
    s_add_u32 s6, s6, 1
    s_cmp_lt_u32 s6, 32
    s_cbranch_scc1 L_DMA
    s_waitcnt vmcnt(0) lgkmcnt(0)
    s_waitcnt vmcnt(0)
    s_barrier
L_END:
    s_endpgm
.section .rodata,"a"
.p2align 6
.amdhsa_kernel parallel_sum__mha_block_cached__glu_gated_glu__decode_kernel
  .amdhsa_next_free_vgpr 168
  .amdhsa_next_free_sgpr 100
  .amdhsa_accum_offset 168
  .amdhsa_group_segment_fixed_size 0
  .amdhsa_kernarg_size 96
  .amdhsa_user_sgpr_count 2
  .amdhsa_user_sgpr_kernarg_segment_ptr 1
  .amdhsa_system_sgpr_workgroup_id_x 1
.end_amdhsa_kernel
```
